```python
import torch

def _softmax(x, axis=-1):
    return torch.softmax(x, dim=axis)
def _gelu(x):
    return torch.nn.functional.gelu(x, approximate="tanh")
def _silu(x):
    return torch.nn.functional.silu(x)
def _sigmoid(x):
    return torch.sigmoid(x)
def _layernorm(x, axis=-1, eps=1e-5):
    m = x.mean(dim=axis, keepdim=True)
    v = x.var(dim=axis, keepdim=True, unbiased=False)
    return (x - m) / torch.sqrt(v + eps)
def _scatter_add(tgt, idx, src, axis=0):
    return tgt.clone().index_add_(axis, idx, src)
def _segment_sum(src, seg, n):
    out = torch.zeros((n,) + src.shape[1:], dtype=src.dtype)
    return out.index_add_(0, seg, src)
def _pad(x, pw):
    flat = tuple(v for pair in reversed(pw) for v in pair)
    return torch.nn.functional.pad(x, flat)

kernel_name = 'sequential_preLN__mha_block_cached__mixer_token_mlp__decode'

def setup_inputs():

    _w = (lambda a: (lambda t: t.to(torch.bfloat16) if t.is_floating_point() else t)(torch.as_tensor(a)))
    def _A_setup():
        B, Sq, D = 4, 1, 640
        H, Sk, Dh = 32, 4096, 192
        return {
            "x": _w((lambda *s: torch.randn(*s, dtype=torch.bfloat16) * 0.05)(B, Sq, D)),
            "k_cache": _w((lambda *s: torch.randn(*s, dtype=torch.bfloat16) * 1.6)(B, H, Sk, Dh)),
            "v_cache": _w((lambda *s: torch.randn(*s, dtype=torch.bfloat16) * 0.8)(B, H, Sk, Dh)),
            "wq": _w((lambda *s: torch.randn(*s, dtype=torch.bfloat16) * 1.6)(D, H * Dh) * (D ** -0.5)),
            "wo": _w((lambda *s: torch.randn(*s, dtype=torch.bfloat16) * 0.8)(H * Dh, D) * ((H * Dh) ** -0.5)),
        }
    _A_in = _A_setup()

    def _B_setup():
        B, S, D, F = 4, 1, 640, 1536
        return {
            "x": _w((lambda *s: torch.randn(*s, dtype=torch.bfloat16) * 0.05)(B, S, D)),
            "w1": _w((lambda *s: torch.randn(*s, dtype=torch.bfloat16) * 3.2)(S, F) * (S ** -0.5)),
            "b1": _w((lambda *s: torch.randn(*s, dtype=torch.bfloat16) * 3.2)(F) * 0.02),
            "w2": _w((lambda *s: torch.randn(*s, dtype=torch.bfloat16) * 0.4)(F, S) * (F ** -0.5)),
            "b2": _w((lambda *s: torch.randn(*s, dtype=torch.bfloat16) * 0.4)(S) * 0.02),
        }
    _B_in = _B_setup()

    return {
        "A_x": _A_in["x"],
        "A_k_cache": _A_in["k_cache"],
        "A_v_cache": _A_in["v_cache"],
        "A_wq": _A_in["wq"],
        "A_wo": _A_in["wo"],
        "B_x": _B_in["x"],
        "B_w1": _B_in["w1"],
        "B_b1": _B_in["b1"],
        "B_w2": _B_in["w2"],
        "B_b2": _B_in["b2"],
    }

def reference(A_x, A_k_cache, A_v_cache, A_wq, A_wo, B_x, B_w1, B_b1, B_w2, B_b2):
    def _A_ref(x, k_cache, v_cache, wq, wo):
        B, Sq, D = x.shape
        H, Dh = 32, 192
        q = (lambda x, *d: x.permute(*d))((x @ wq).reshape(B, Sq, H, Dh), 0, 2, 1, 3)
        scores = torch.einsum("bhqd,bhkd->bhqk", q, k_cache) * (Dh ** -0.5)
        p = _softmax(scores, axis=-1)
        o = torch.einsum("bhqk,bhkd->bhqd", p, v_cache)
        return (lambda x, *d: x.permute(*d))(o, 0, 2, 1, 3).reshape(B, Sq, H * Dh) @ wo

    def _B_ref(x, w1, b1, w2, b2):
        B, S, D = x.shape
        h = _layernorm(x, axis=-1)
        u = torch.einsum("bsd,sf->bdf", h, w1) + b1
        u = _gelu(u)
        y = torch.einsum("bdf,fs->bds", u, w2) + b2
        return (lambda x, *d: x.permute(*d))(y, 0, 2, 1)

    x = A_x
    h = x + _A_ref(_layernorm(x, axis=-1), A_k_cache, A_v_cache, A_wq, A_wo)
    h2 = h + _B_ref(_layernorm(h, axis=-1), B_w1, B_b1, B_w2, B_b2)
    return h2
```

```asm
; @launch grid=(256,1,1) block=(256,1,1) lds=121216
.amdgcn_target "amdgcn-amd-amdhsa--gfx950"
.text
.globl sequential_preLN__mha_block_cached__mixer_token_mlp__decode_kernel
.p2align 8
.type sequential_preLN__mha_block_cached__mixer_token_mlp__decode_kernel,@function
sequential_preLN__mha_block_cached__mixer_token_mlp__decode_kernel:
  s_cmp_ge_u32 s2, 256
  s_cbranch_scc1 L_end
  s_load_dwordx8 s[8:15], s[0:1], 0
  s_load_dwordx2 s[16:17], s[0:1], 32
  s_load_dwordx2 s[22:23], s[0:1], 96
  v_lshrrev_b32 v19, 6, v0
  v_and_b32 v1, 63, v0
  v_readfirstlane_b32 s52, v19
  s_and_b32 s54, s2, 7
  s_lshr_b32 s57, s2, 3
  s_lshl_b32 s54, s54, 2
  s_and_b32 s58, s57, 3
  s_add_u32 s54, s54, s58
  s_lshr_b32 s49, s57, 2
  s_lshr_b32 s53, s57, 3
  s_and_b32 s55, s49, 1
  s_lshl_b32 s56, s53, 5
  s_add_u32 s56, s56, s54
  v_lshrrev_b32 v19, 4, v1
  v_and_b32 v20, 15, v1
  v_lshrrev_b32 v21, 2, v20
  v_mul_u32_u24 v2, 768, v21
  v_lshl_add_u32 v2, v19, 6, v2
  v_and_b32 v21, 3, v20
  v_lshl_add_u32 v2, v21, 4, v2
  v_mul_u32_u24 v3, 768, v19
  v_lshl_add_u32 v3, v20, 4, v3
  v_lshrrev_b32 v4, 3, v1
  v_mul_u32_u24 v4, 12288, v4
  v_and_b32 v5, 7, v1
  v_lshl_add_u32 v4, v5, 4, v4
  v_mul_u32_u24 v7, 1280, v19
  v_lshl_add_u32 v7, v20, 4, v7
  v_mov_b32 v40, 0
  v_mov_b32 v41, 0
  v_mov_b32 v42, 0
  v_mov_b32 v43, 0
  v_mov_b32 v44, 0
  v_mov_b32 v45, 0
  v_mov_b32 v46, 0
  v_mov_b32 v47, 0
  v_mov_b32 v48, 0
  v_mov_b32 v49, 0
  v_mov_b32 v50, 0
  v_mov_b32 v51, 0
  v_lshlrev_b32 v21, 4, v0
  v_lshlrev_b32 v22, 2, v1
  s_lshl_b32 s58, s56, 1
  s_add_u32 s58, s58, s55
  s_mul_i32 s59, s55, 56
  s_mul_i32 s57, s54, 48
  s_add_u32 s59, s59, s57
  s_mul_i32 s57, s53, 48
  s_add_u32 s59, s59, s57
  s_and_b32 s59, s59, 63
  s_mov_b32 s60, s59
  s_mul_i32 s58, s58, 786432
  s_mul_i32 s61, s52, 3072
  s_mul_i32 s62, s54, 384
  s_mul_i32 s63, s49, 240
  s_lshl_b32 s57, s52, 3
  s_add_u32 s65, s63, s57
  s_mul_i32 s57, s65, 1639
  s_lshr_b32 s57, s57, 20
  s_mul_i32 s66, s57, 640
  s_sub_u32 s65, s65, s66
  s_mul_i32 s65, s65, 12288
  s_lshl_b32 s57, s57, 7
  s_add_u32 s65, s65, s57
  s_lshr_b32 s57, s52, 1
  s_mul_i32 s64, s57, 122880
  s_and_b32 s57, s52, 1
  s_mul_i32 s57, s57, 5120
  s_add_u32 s64, s64, s57
  s_mul_i32 s57, s52, 1280
  s_mov_b32 s51, 0
  s_waitcnt lgkmcnt(0)
  s_add_u32 s24, s8, s57
  s_addc_u32 s25, s9, 0
  s_mov_b32 s26, 1280
  s_mov_b32 s27, 0x20000
  buffer_load_dword v95, v22, s[24:27], 0 offen offset:0
  buffer_load_dword v96, v22, s[24:27], 0 offen offset:256
  buffer_load_dword v97, v22, s[24:27], 0 offen offset:512
  buffer_load_dword v98, v22, s[24:27], 0 offen offset:768
  buffer_load_dword v99, v22, s[24:27], 0 offen offset:1024
  s_add_u32 s36, s14, s62
  s_addc_u32 s37, s15, 0
  s_mov_b32 s38, 7852416
  s_mov_b32 s39, 0x20000
  buffer_load_dwordx4 a[204:207], v4, s[36:39], s65 offen nt
  s_add_u32 s65, s65, 393216
  s_cmp_ge_u32 s65, 7864320
  s_cselect_b32 s66, 7864192, 0
  s_sub_u32 s65, s65, s66
  buffer_load_dwordx4 a[208:211], v4, s[36:39], s65 offen nt
  s_add_u32 s65, s65, 393216
  s_cmp_ge_u32 s65, 7864320
  s_cselect_b32 s66, 7864192, 0
  s_sub_u32 s65, s65, s66
  buffer_load_dwordx4 a[212:215], v4, s[36:39], s65 offen nt
  s_add_u32 s65, s65, 393216
  s_cmp_ge_u32 s65, 7864320
  s_cselect_b32 s66, 7864192, 0
  s_sub_u32 s65, s65, s66
  buffer_load_dwordx4 a[216:219], v4, s[36:39], s65 offen nt
  s_add_u32 s65, s65, 393216
  s_cmp_ge_u32 s65, 7864320
  s_cselect_b32 s66, 7864192, 0
  s_sub_u32 s65, s65, s66
  buffer_load_dwordx4 a[220:223], v4, s[36:39], s65 offen nt
  s_add_u32 s65, s65, 393216
  s_cmp_ge_u32 s65, 7864320
  s_cselect_b32 s66, 7864192, 0
  s_sub_u32 s65, s65, s66
  buffer_load_dwordx4 a[224:227], v4, s[36:39], s65 offen nt
  s_add_u32 s65, s65, 393216
  s_cmp_ge_u32 s65, 7864320
  s_cselect_b32 s66, 7864192, 0
  s_sub_u32 s65, s65, s66
  buffer_load_dwordx4 a[228:231], v4, s[36:39], s65 offen nt
  s_add_u32 s65, s65, 393216
  s_cmp_ge_u32 s65, 7864320
  s_cselect_b32 s66, 7864192, 0
  s_sub_u32 s65, s65, s66
  s_cmp_ge_u32 s52, 2
  s_cselect_b32 s65, 0x7000000, s65
  buffer_load_dwordx4 a[232:235], v4, s[36:39], s65 offen nt
  s_add_u32 s28, s10, s58
  s_addc_u32 s29, s11, 0
  s_mov_b32 s30, 786432
  s_mov_b32 s31, 0x20000
  s_add_u32 s32, s12, s58
  s_addc_u32 s33, s13, 0
  s_mov_b32 s34, 786432
  s_mov_b32 s35, 0x20000
  s_mul_i32 s57, s54, 245760
  s_add_u32 s40, s16, s57
  s_addc_u32 s41, s17, 0
  s_mov_b32 s42, 245760
  s_mov_b32 s43, 0x20000
  s_mov_b32 s44, s22
  s_mov_b32 s45, s23
  s_mov_b32 s46, 2097152
  s_mov_b32 s47, 0x20000
  s_load_dwordx8 s[8:15], s[0:1], 48
  s_load_dwordx2 s[20:21], s[0:1], 80
  s_load_dword s48, s[22:23], 45056
  s_mul_i32 s62, s49, 30720
  s_mul_i32 s57, s52, 7680
  s_add_u32 s62, s62, s57
  v_lshlrev_b32 v18, 4, v1
  buffer_load_dwordx4 a[160:163], v18, s[40:43], s62 offen offset:0 nt
  buffer_load_dwordx4 a[120:123], v18, s[40:43], s62 offen offset:0 sc1
  buffer_load_dwordx4 a[164:167], v18, s[40:43], s62 offen offset:1024 nt
  buffer_load_dwordx4 a[124:127], v18, s[40:43], s62 offen offset:1024 sc1
  buffer_load_dwordx4 a[168:171], v18, s[40:43], s62 offen offset:2048 nt
  buffer_load_dwordx4 a[128:131], v18, s[40:43], s62 offen offset:2048 sc1
  buffer_load_dwordx4 a[172:175], v18, s[40:43], s62 offen offset:3072 nt
  buffer_load_dwordx4 a[132:135], v18, s[40:43], s62 offen offset:3072 sc1
  s_add_u32 s62, s62, 4096
  buffer_load_dwordx4 a[176:179], v18, s[40:43], s62 offen offset:0 nt
  buffer_load_dwordx4 a[136:139], v18, s[40:43], s62 offen offset:0 sc1
  buffer_load_dwordx4 a[180:183], v18, s[40:43], s62 offen offset:1024 nt
  buffer_load_dwordx4 a[140:143], v18, s[40:43], s62 offen offset:1024 sc1
  buffer_load_dwordx4 a[184:187], v18, s[40:43], s62 offen offset:2048 nt
  buffer_load_dwordx4 a[144:147], v18, s[40:43], s62 offen offset:2048 sc1
  s_mov_b32 exec_lo, 0xffffffff
  s_mov_b32 exec_hi, 0x00000000
  buffer_load_dwordx4 a[188:191], v18, s[40:43], s62 offen offset:3072 nt
  buffer_load_dwordx4 a[148:151], v18, s[40:43], s62 offen offset:3072 sc1
  s_mov_b64 exec, -1
  s_mul_i32 s62, s59, 12288
  s_add_u32 s62, s62, s61
  buffer_load_dwordx4 v[100:103], v2, s[28:31], s62 offen offset:0 nt
  buffer_load_dwordx4 v[104:107], v2, s[28:31], s62 offen offset:256 nt
  buffer_load_dwordx4 v[108:111], v2, s[28:31], s62 offen offset:512 nt
  s_add_u32 s59, s59, 1
  s_and_b32 s59, s59, 63
  s_cmp_lg_u32 s2, 0
  s_cbranch_scc1 L_nozero
  s_movk_i32 s57, 0
  buffer_store_dwordx4 v[40:43], v21, s[44:47], s57 offen sc1
  s_movk_i32 s57, 4096
  buffer_store_dwordx4 v[40:43], v21, s[44:47], s57 offen sc1
  s_movk_i32 s57, 8192
  buffer_store_dwordx4 v[40:43], v21, s[44:47], s57 offen sc1
  s_movk_i32 s57, 12288
  buffer_store_dwordx4 v[40:43], v21, s[44:47], s57 offen sc1
L_nozero:
  s_waitcnt lgkmcnt(0)
  s_mov_b32 s16, s8
  s_mov_b32 s17, s9
  s_mov_b32 s18, 3072
  s_mov_b32 s19, 0x20000
  buffer_load_dwordx4 v[52:55], v21, s[16:19], 0 offen
  s_mov_b32 s16, s10
  s_mov_b32 s17, s11
  s_mov_b32 s18, 3072
  s_mov_b32 s19, 0x20000
  buffer_load_dwordx4 v[56:59], v21, s[16:19], 0 offen
  s_mov_b32 s16, s12
  s_mov_b32 s17, s13
  s_mov_b32 s18, 3072
  s_mov_b32 s19, 0x20000
  buffer_load_dwordx4 v[36:39], v21, s[16:19], 0 offen
  s_load_dword s69, s[14:15], 0
  s_mul_i32 s48, s48, 0x2c9277b5
  s_add_u32 s48, s48, 0x7f4a7c15
  v_and_b32 v21, 7, v1
  v_and_b32 v22, 1, v1
  v_cmp_eq_u32 vcc, 1, v22
  v_mov_b32 v23, 0xffff
  v_mov_b32 v11, 0xffff0000
  v_cndmask_b32 v23, v23, v11, vcc
  v_lshrrev_b32 v22, 1, v21
  v_cmp_eq_u32 vcc, 0, v22
  s_nop 1
  v_cndmask_b32 v8, 0, v23, vcc
  v_cmp_eq_u32 vcc, 1, v22
  s_nop 1
  v_cndmask_b32 v9, 0, v23, vcc
  v_cmp_eq_u32 vcc, 2, v22
  s_nop 1
  v_cndmask_b32 v10, 0, v23, vcc
  v_cmp_eq_u32 vcc, 3, v22
  s_nop 1
  v_cndmask_b32 v11, 0, v23, vcc
  v_lshl_add_u32 v14, v19, 3, v21
  v_lshlrev_b32 v14, 4, v14
  s_mul_i32 s57, s52, 1536
  v_add_u32 v12, s57, v14
  s_mul_i32 s57, s52, 2560
  v_lshrrev_b32 v22, 3, v1
  v_lshl_add_u32 v16, v22, 2, s57
  s_lshl_b32 s57, s52, 11
  s_add_u32 s57, s57, 47488
  v_lshl_add_u32 v15, v22, 2, s57
  v_mov_b32 v17, 0xff800000
  v_lshlrev_b32 v13, 2, v0
  s_lshl_b32 s57, s2, 2
  s_add_u32 s57, s57, s52
  s_lshr_b32 s58, s57, 9
  s_lshl_b32 s58, s58, 15
  s_and_b32 s57, s57, 511
  s_lshl_b32 s57, s57, 3
  s_add_u32 s57, s57, 12800
  s_or_b32 s3, s57, s58
  v_add_lshl_u32 v88, v21, s3, 16
  v_mov_b32 v89, v88
  v_mov_b32 v90, 0
  v_mov_b32 v91, 0
  v_mov_b32 v92, 0xbdd2d3e8
  v_mov_b32 v93, 0xbdd2d3e8
  s_mov_b32 s70, 0xc0135761
  s_mov_b32 s71, 0xc0135761
  s_mov_b32 s72, 1.0
  s_mov_b32 s73, 1.0
  v_mul_u32_u24 v94, 2320, v22
  v_add_u32 v94, 18432, v94
  s_mul_i32 s62, s59, 12288
  s_add_u32 s62, s62, s61
  buffer_load_dwordx4 v[112:115], v2, s[28:31], s62 offen offset:0 nt
  buffer_load_dwordx4 v[116:119], v2, s[28:31], s62 offen offset:256 nt
  buffer_load_dwordx4 v[120:123], v2, s[28:31], s62 offen offset:512 nt
  s_add_u32 s59, s59, 1
  s_and_b32 s59, s59, 63
  s_mul_i32 s62, s59, 12288
  s_add_u32 s62, s62, s61
  buffer_load_dwordx4 v[124:127], v2, s[28:31], s62 offen offset:0 nt
  buffer_load_dwordx4 v[128:131], v2, s[28:31], s62 offen offset:256 nt
  buffer_load_dwordx4 v[132:135], v2, s[28:31], s62 offen offset:512 nt
  s_add_u32 s59, s59, 1
  s_and_b32 s59, s59, 63
  s_mul_i32 s62, s59, 12288
  s_add_u32 s62, s62, s61
  buffer_load_dwordx4 v[136:139], v2, s[28:31], s62 offen offset:0 nt
  buffer_load_dwordx4 v[140:143], v2, s[28:31], s62 offen offset:256 nt
  buffer_load_dwordx4 v[144:147], v2, s[28:31], s62 offen offset:512 nt
  s_add_u32 s59, s59, 1
  s_and_b32 s59, s59, 63
  s_waitcnt vmcnt(39)
  v_lshlrev_b32 v64, 16, v95
  v_and_b32 v65, 0xffff0000, v95
  v_lshlrev_b32 v66, 16, v96
  v_and_b32 v67, 0xffff0000, v96
  v_lshlrev_b32 v68, 16, v97
  v_and_b32 v69, 0xffff0000, v97
  v_lshlrev_b32 v70, 16, v98
  v_and_b32 v71, 0xffff0000, v98
  v_lshlrev_b32 v72, 16, v99
  v_and_b32 v73, 0xffff0000, v99
  s_nop 0
  v_readfirstlane_b32 s6, v64
  v_readfirstlane_b32 s7, v64
  s_nop 1
  v_pk_add_f32 v[24:25], v[64:65], s[6:7] neg_lo:[0,1] neg_hi:[0,1]
  v_pk_add_f32 v[26:27], v[66:67], s[6:7] neg_lo:[0,1] neg_hi:[0,1]
  v_pk_add_f32 v[28:29], v[68:69], s[6:7] neg_lo:[0,1] neg_hi:[0,1]
  v_pk_add_f32 v[30:31], v[70:71], s[6:7] neg_lo:[0,1] neg_hi:[0,1]
  v_pk_add_f32 v[32:33], v[72:73], s[6:7] neg_lo:[0,1] neg_hi:[0,1]
  v_pk_add_f32 v[74:75], v[24:25], v[26:27]
  v_pk_mul_f32 v[76:77], v[24:25], v[24:25]
  v_pk_add_f32 v[78:79], v[28:29], v[30:31]
  v_pk_fma_f32 v[76:77], v[26:27], v[26:27], v[76:77]
  v_pk_add_f32 v[74:75], v[74:75], v[32:33]
  v_pk_fma_f32 v[76:77], v[28:29], v[28:29], v[76:77]
  v_pk_add_f32 v[74:75], v[74:75], v[78:79]
  v_pk_fma_f32 v[76:77], v[30:31], v[30:31], v[76:77]
  v_add_f32 v74, v74, v75
  v_pk_fma_f32 v[76:77], v[32:33], v[32:33], v[76:77]
  v_mov_b32 v78, 0x3acccccd
  v_add_f32 v76, v76, v77
  s_nop 0
  v_add_f32_dpp v74, v74, v74 quad_perm:[1,0,3,2] row_mask:0xf bank_mask:0xf
  v_add_f32_dpp v76, v76, v76 quad_perm:[1,0,3,2] row_mask:0xf bank_mask:0xf
  s_nop 0
  v_add_f32_dpp v74, v74, v74 quad_perm:[2,3,0,1] row_mask:0xf bank_mask:0xf
  v_add_f32_dpp v76, v76, v76 quad_perm:[2,3,0,1] row_mask:0xf bank_mask:0xf
  s_nop 0
  v_add_f32_dpp v74, v74, v74 row_half_mirror row_mask:0xf bank_mask:0xf
  v_add_f32_dpp v76, v76, v76 row_half_mirror row_mask:0xf bank_mask:0xf
  s_nop 0
  v_add_f32_dpp v74, v74, v74 row_mirror row_mask:0xf bank_mask:0xf
  v_add_f32_dpp v76, v76, v76 row_mirror row_mask:0xf bank_mask:0xf
  s_nop 0
  v_add_f32_dpp v74, v74, v74 row_bcast:15 row_mask:0xa bank_mask:0xf
  v_add_f32_dpp v76, v76, v76 row_bcast:15 row_mask:0xa bank_mask:0xf
  s_nop 0
  v_add_f32_dpp v74, v74, v74 row_bcast:31 row_mask:0xc bank_mask:0xf
  v_add_f32_dpp v76, v76, v76 row_bcast:31 row_mask:0xc bank_mask:0xf
  v_readlane_b32 s4, v74, 63
  v_readlane_b32 s5, v76, 63
  s_nop 1
  v_mul_f32 v74, s4, v78
  v_mul_f32 v76, s5, v78
  v_fma_f32 v76, -v74, v74, v76
  v_add_f32 v74, s6, v74
  v_max_f32 v76, 0, v76
  v_cvt_pk_bf16_f32 v74, 0, v74
  v_cvt_pk_bf16_f32 v76, 0, v76
  v_mov_b32 v75, v74
  v_add_f32 v76, 0x3727c5ac, v76
  v_pk_add_f32 v[24:25], v[64:65], v[74:75] neg_lo:[0,1] neg_hi:[0,1]
  v_cvt_pk_bf16_f32 v76, 0, v76
  v_pk_add_f32 v[26:27], v[66:67], v[74:75] neg_lo:[0,1] neg_hi:[0,1]
  v_sqrt_f32 v76, v76
  v_pk_add_f32 v[28:29], v[68:69], v[74:75] neg_lo:[0,1] neg_hi:[0,1]
  v_pk_add_f32 v[30:31], v[70:71], v[74:75] neg_lo:[0,1] neg_hi:[0,1]
  v_pk_add_f32 v[32:33], v[72:73], v[74:75] neg_lo:[0,1] neg_hi:[0,1]
  v_cvt_pk_bf16_f32 v76, 0, v76
  v_cvt_pk_bf16_f32 v24, 0, v24
  v_rcp_f32 v76, v76
  v_cvt_pk_bf16_f32 v25, 0, v25
  v_cvt_pk_bf16_f32 v26, 0, v26
  v_cvt_pk_bf16_f32 v27, 0, v27
  v_cvt_pk_bf16_f32 v28, 0, v28
  v_cvt_pk_bf16_f32 v29, 0, v29
  v_cvt_pk_bf16_f32 v30, 0, v30
  v_cvt_pk_bf16_f32 v31, 0, v31
  v_cvt_pk_bf16_f32 v32, 0, v32
  v_cvt_pk_bf16_f32 v33, 0, v33
  v_mov_b32 v77, v76
  v_pk_mul_f32 v[24:25], v[24:25], v[76:77]
  v_pk_mul_f32 v[26:27], v[26:27], v[76:77]
  v_pk_mul_f32 v[28:29], v[28:29], v[76:77]
  v_pk_mul_f32 v[30:31], v[30:31], v[76:77]
  v_pk_mul_f32 v[32:33], v[32:33], v[76:77]
  v_cvt_pk_bf16_f32 v24, 0, v24
  v_cvt_pk_bf16_f32 v25, 0, v25
  v_cvt_pk_bf16_f32 v26, 0, v26
  v_cvt_pk_bf16_f32 v27, 0, v27
  v_cvt_pk_bf16_f32 v28, 0, v28
  v_cvt_pk_bf16_f32 v29, 0, v29
  v_cvt_pk_bf16_f32 v30, 0, v30
  v_cvt_pk_bf16_f32 v31, 0, v31
  v_cvt_pk_bf16_f32 v32, 0, v32
  v_cvt_pk_bf16_f32 v33, 0, v33
  s_mul_i32 s57, s52, 2560
  v_lshl_add_u32 v21, v1, 3, s57
  v_cvt_pk_bf16_f32 v24, v24, v24
  v_cvt_pk_bf16_f32 v25, v25, v25
  v_cvt_pk_bf16_f32 v26, v26, v26
  v_cvt_pk_bf16_f32 v27, v27, v27
  v_cvt_pk_bf16_f32 v28, v28, v28
  v_cvt_pk_bf16_f32 v29, v29, v29
  v_cvt_pk_bf16_f32 v30, v30, v30
  v_cvt_pk_bf16_f32 v31, v31, v31
  v_cvt_pk_bf16_f32 v32, v32, v32
  v_cvt_pk_bf16_f32 v33, v33, v33
  ds_write_b64 v21, v[24:25] offset:0
  ds_write_b64 v21, v[26:27] offset:512
  ds_write_b64 v21, v[28:29] offset:1024
  ds_write_b64 v21, v[30:31] offset:1536
  ds_write_b64 v21, v[32:33] offset:2048
  v_lshlrev_b32 v18, 4, v1
  s_lshl_b32 s57, s52, 10
  s_add_u32 s57, s57, 59776
  v_add_u32 v21, s57, v18
  s_waitcnt vmcnt(31)
  s_waitcnt lgkmcnt(0)
  ds_write_b128 v21, a[204:207] offset:0
  ds_write_b128 v21, a[208:211] offset:4096
  ds_write_b128 v21, a[212:215] offset:8192
  ds_write_b128 v21, a[216:219] offset:12288
  ds_write_b128 v21, a[220:223] offset:16384
  ds_write_b128 v21, a[224:227] offset:20480
  ds_write_b128 v21, a[228:231] offset:24576
  ds_write_b128 v21, a[232:235] offset:28672
  s_mul_i32 s62, s59, 12288
  s_add_u32 s62, s62, s61
  buffer_load_dwordx4 v[148:151], v2, s[28:31], s62 offen offset:0 nt
  buffer_load_dwordx4 v[152:155], v2, s[28:31], s62 offen offset:256 nt
  buffer_load_dwordx4 v[156:159], v2, s[28:31], s62 offen offset:512 nt
  s_add_u32 s59, s59, 1
  s_and_b32 s59, s59, 63
  s_waitcnt vmcnt(12)
  s_waitcnt lgkmcnt(0)
  s_cmp_eq_u32 s52, 3
  s_cbranch_scc1 L_now
  v_lshlrev_b32 v64, 16, v52
  v_and_b32 v65, 0xffff0000, v52
  v_lshlrev_b32 v66, 16, v53
  v_and_b32 v67, 0xffff0000, v53
  v_lshlrev_b32 v68, 16, v54
  v_and_b32 v69, 0xffff0000, v54
  v_lshlrev_b32 v70, 16, v55
  v_and_b32 v71, 0xffff0000, v55
  v_lshlrev_b32 v72, 16, v56
  v_and_b32 v73, 0xffff0000, v56
  v_lshlrev_b32 v74, 16, v57
  v_and_b32 v75, 0xffff0000, v57
  v_lshlrev_b32 v76, 16, v58
  v_and_b32 v77, 0xffff0000, v58
  v_lshlrev_b32 v78, 16, v59
  v_and_b32 v79, 0xffff0000, v59
  v_lshlrev_b32 v80, 16, v36
  v_and_b32 v81, 0xffff0000, v36
  v_lshlrev_b32 v82, 16, v37
  v_and_b32 v83, 0xffff0000, v37
  v_lshlrev_b32 v84, 16, v38
  v_and_b32 v85, 0xffff0000, v38
  v_lshlrev_b32 v86, 16, v39
  v_and_b32 v87, 0xffff0000, v39
  v_mul_u32_u24 v22, 2731, v0
  v_mul_u32_u24 v21, 96, v0
  v_lshrrev_b32 v22, 16, v22
  v_lshl_add_u32 v21, v22, 4, v21
  v_mov_b32 v22, 0
  ds_write_b32 v22, v22 offset:37120
  ds_write_b128 v21, v[64:67] offset:18432
  ds_write_b128 v21, v[68:71] offset:18448
  ds_write_b128 v21, v[72:75] offset:18464
  ds_write_b128 v21, v[76:79] offset:18480
  ds_write_b128 v21, v[80:83] offset:18496
  ds_write_b128 v21, v[84:87] offset:18512
  s_waitcnt lgkmcnt(0)
L_now:
  s_add_u32 s57, s63, 0
  s_mul_i32 s58, s57, 1639
  s_lshr_b32 s58, s58, 20
  s_mul_i32 s58, s58, 640
  s_sub_u32 s57, s57, s58
  s_lshl_b32 s57, s57, 2
  v_add_u32 v22, s57, v16
  ds_read_b32 v24, v22 offset:0
  ds_read_b32 v25, v22 offset:32
  ds_read_b32 v26, v22 offset:64
  ds_read_b32 v27, v22 offset:96
  ds_read_b32 v28, v22 offset:128
  ds_read_b32 v29, v22 offset:160
  ds_read_b32 v30, v22 offset:192
  ds_read_b32 v31, v22 offset:224
  ds_read_b32 v32, v22 offset:256
  ds_read_b32 v33, v22 offset:288
  s_add_u32 s57, s63, 80
  s_mul_i32 s58, s57, 1639
  s_lshr_b32 s58, s58, 20
  s_mul_i32 s58, s58, 640
  s_sub_u32 s57, s57, s58
  s_lshl_b32 s57, s57, 2
  v_add_u32 v22, s57, v16
  s_waitcnt lgkmcnt(4)
  ds_read_b32 v64, v22 offset:0
  ds_read_b32 v65, v22 offset:32
  ds_read_b32 v66, v22 offset:64
  ds_read_b32 v67, v22 offset:96
  ds_read_b32 v68, v22 offset:128
  ds_read_b32 v69, v22 offset:160
  ds_read_b32 v70, v22 offset:192
  ds_read_b32 v71, v22 offset:224
  ds_read_b32 v72, v22 offset:256
  ds_read_b32 v73, v22 offset:288
  s_add_u32 s57, s63, 160
  s_mul_i32 s58, s57, 1639
  s_lshr_b32 s58, s58, 20
  s_mul_i32 s58, s58, 640
  s_sub_u32 s57, s57, s58
  s_lshl_b32 s57, s57, 2
  v_add_u32 v22, s57, v16
  s_waitcnt lgkmcnt(4)
  ds_read_b32 v74, v22 offset:0
  ds_read_b32 v75, v22 offset:32
  ds_read_b32 v76, v22 offset:64
  ds_read_b32 v77, v22 offset:96
  ds_read_b32 v78, v22 offset:128
  ds_read_b32 v79, v22 offset:160
  ds_read_b32 v80, v22 offset:192
  ds_read_b32 v81, v22 offset:224
  ds_read_b32 v82, v22 offset:256
  ds_read_b32 v83, v22 offset:288
  v_add_u32 v21, 59776, v18
  v_mov_b32 v23, 0
  s_waitcnt lgkmcnt(0)
  s_barrier
  s_or_b32 s57, s2, s52
  s_cmp_lg_u32 s57, 0
  s_cbranch_scc1 L_noflag
  v_mov_b32 v60, s48
  v_mov_b32 v61, s48
  v_mov_b32 v62, s48
  v_mov_b32 v63, s48
  s_mov_b32 s57, 45312
  s_mov_b64 exec, 1
  buffer_store_dwordx4 v[60:63], v23, s[44:47], s57 offen sc1
  s_mov_b64 exec, -1
L_noflag:
  ds_read_b128 a[204:207], v21 offset:0
  ds_read_b128 a[208:211], v21 offset:1024
  ds_read_b128 a[212:215], v21 offset:2048
  ds_read_b128 a[216:219], v21 offset:3072
  ds_read_b128 a[220:223], v21 offset:4096
  ds_read_b128 a[224:227], v21 offset:5120
  ds_read_b128 a[228:231], v21 offset:6144
  s_mul_i32 s62, s59, 12288
  s_add_u32 s62, s62, s61
  buffer_load_dwordx4 v[160:163], v2, s[28:31], s62 offen offset:0 nt
  buffer_load_dwordx4 v[164:167], v2, s[28:31], s62 offen offset:256 nt
  buffer_load_dwordx4 v[168:171], v2, s[28:31], s62 offen offset:512 nt
  s_add_u32 s59, s59, 1
  s_and_b32 s59, s59, 63
  v_and_b32 v52, v24, v8
  v_and_b32 v53, v24, v9
  v_and_b32 v54, v24, v10
  v_and_b32 v55, v24, v11
  ds_read_b128 a[232:235], v21 offset:7168
  s_waitcnt lgkmcnt(7)
  v_mfma_f32_16x16x32_bf16 v[40:43], a[204:207], v[52:55], v[40:43]
  v_and_b32 v56, v25, v8
  v_and_b32 v57, v25, v9
  v_and_b32 v58, v25, v10
  v_and_b32 v59, v25, v11
  ds_read_b128 a[204:207], v21 offset:8192
  s_waitcnt lgkmcnt(7)
  v_mfma_f32_16x16x32_bf16 v[40:43], a[208:211], v[56:59], v[40:43]
  v_and_b32 v52, v26, v8
  v_and_b32 v53, v26, v9
  v_and_b32 v54, v26, v10
  v_and_b32 v55, v26, v11
  ds_read_b128 a[208:211], v21 offset:9216
  s_waitcnt lgkmcnt(7)
  v_mfma_f32_16x16x32_bf16 v[40:43], a[212:215], v[52:55], v[40:43]
  v_and_b32 v56, v27, v8
  v_and_b32 v57, v27, v9
  v_and_b32 v58, v27, v10
  v_and_b32 v59, v27, v11
  ds_read_b128 a[212:215], v21 offset:10240
  s_waitcnt lgkmcnt(7)
  v_mfma_f32_16x16x32_bf16 v[40:43], a[216:219], v[56:59], v[40:43]
  v_and_b32 v52, v28, v8
  v_and_b32 v53, v28, v9
  v_and_b32 v54, v28, v10
  v_and_b32 v55, v28, v11
  ds_read_b128 a[216:219], v21 offset:11264
  s_waitcnt lgkmcnt(7)
  v_mfma_f32_16x16x32_bf16 v[40:43], a[220:223], v[52:55], v[40:43]
  v_and_b32 v56, v29, v8
  v_and_b32 v57, v29, v9
  v_and_b32 v58, v29, v10
  v_and_b32 v59, v29, v11
  ds_read_b128 a[220:223], v21 offset:12288
  s_waitcnt lgkmcnt(7)
  v_mfma_f32_16x16x32_bf16 v[40:43], a[224:227], v[56:59], v[40:43]
  v_and_b32 v52, v30, v8
  v_and_b32 v53, v30, v9
  v_and_b32 v54, v30, v10
  v_and_b32 v55, v30, v11
  ds_read_b128 a[224:227], v21 offset:13312
  s_waitcnt lgkmcnt(7)
  v_mfma_f32_16x16x32_bf16 v[40:43], a[228:231], v[52:55], v[40:43]
  v_and_b32 v56, v31, v8
  v_and_b32 v57, v31, v9
  v_and_b32 v58, v31, v10
  v_and_b32 v59, v31, v11
  ds_read_b128 a[228:231], v21 offset:14336
  s_waitcnt lgkmcnt(7)
  v_mfma_f32_16x16x32_bf16 v[40:43], a[232:235], v[56:59], v[40:43]
  v_and_b32 v52, v32, v8
  v_and_b32 v53, v32, v9
  v_and_b32 v54, v32, v10
  v_and_b32 v55, v32, v11
  ds_read_b128 a[232:235], v21 offset:15360
  s_waitcnt lgkmcnt(7)
  v_mfma_f32_16x16x32_bf16 v[40:43], a[204:207], v[52:55], v[40:43]
  v_and_b32 v56, v33, v8
  v_and_b32 v57, v33, v9
  v_and_b32 v58, v33, v10
  v_and_b32 v59, v33, v11
  ds_read_b128 a[204:207], v21 offset:16384
  s_waitcnt lgkmcnt(7)
  v_mfma_f32_16x16x32_bf16 v[40:43], a[208:211], v[56:59], v[40:43]
  v_and_b32 v52, v64, v8
  v_and_b32 v53, v64, v9
  v_and_b32 v54, v64, v10
  v_and_b32 v55, v64, v11
  ds_read_b128 a[208:211], v21 offset:17408
  s_waitcnt lgkmcnt(7)
  v_mfma_f32_16x16x32_bf16 v[44:47], a[212:215], v[52:55], v[44:47]
  s_mul_i32 s62, s59, 12288
  s_add_u32 s62, s62, s61
  buffer_load_dwordx4 v[172:175], v2, s[28:31], s62 offen offset:0 nt
  buffer_load_dwordx4 v[176:179], v2, s[28:31], s62 offen offset:256 nt
  buffer_load_dwordx4 v[180:183], v2, s[28:31], s62 offen offset:512 nt
  s_add_u32 s59, s59, 1
  s_and_b32 s59, s59, 63
  v_and_b32 v56, v65, v8
  v_and_b32 v57, v65, v9
  v_and_b32 v58, v65, v10
  v_and_b32 v59, v65, v11
  ds_read_b128 a[212:215], v21 offset:18432
  s_waitcnt lgkmcnt(7)
  v_mfma_f32_16x16x32_bf16 v[44:47], a[216:219], v[56:59], v[44:47]
  v_and_b32 v52, v66, v8
  v_and_b32 v53, v66, v9
  v_and_b32 v54, v66, v10
  v_and_b32 v55, v66, v11
  ds_read_b128 a[216:219], v21 offset:19456
  s_waitcnt lgkmcnt(7)
  v_mfma_f32_16x16x32_bf16 v[44:47], a[220:223], v[52:55], v[44:47]
  v_and_b32 v56, v67, v8
  v_and_b32 v57, v67, v9
  v_and_b32 v58, v67, v10
  v_and_b32 v59, v67, v11
  ds_read_b128 a[220:223], v21 offset:20480
  s_waitcnt lgkmcnt(7)
  v_mfma_f32_16x16x32_bf16 v[44:47], a[224:227], v[56:59], v[44:47]
  v_and_b32 v52, v68, v8
  v_and_b32 v53, v68, v9
  v_and_b32 v54, v68, v10
  v_and_b32 v55, v68, v11
  ds_read_b128 a[224:227], v21 offset:21504
  s_waitcnt lgkmcnt(7)
  v_mfma_f32_16x16x32_bf16 v[44:47], a[228:231], v[52:55], v[44:47]
  v_and_b32 v56, v69, v8
  v_and_b32 v57, v69, v9
  v_and_b32 v58, v69, v10
  v_and_b32 v59, v69, v11
  ds_read_b128 a[228:231], v21 offset:22528
  s_waitcnt lgkmcnt(7)
  v_mfma_f32_16x16x32_bf16 v[44:47], a[232:235], v[56:59], v[44:47]
  v_and_b32 v52, v70, v8
  v_and_b32 v53, v70, v9
  v_and_b32 v54, v70, v10
  v_and_b32 v55, v70, v11
  ds_read_b128 a[232:235], v21 offset:23552
  s_waitcnt lgkmcnt(7)
  v_mfma_f32_16x16x32_bf16 v[44:47], a[204:207], v[52:55], v[44:47]
  v_and_b32 v56, v71, v8
  v_and_b32 v57, v71, v9
  v_and_b32 v58, v71, v10
  v_and_b32 v59, v71, v11
  ds_read_b128 a[204:207], v21 offset:24576
  s_waitcnt lgkmcnt(7)
  v_mfma_f32_16x16x32_bf16 v[44:47], a[208:211], v[56:59], v[44:47]
  v_and_b32 v52, v72, v8
  v_and_b32 v53, v72, v9
  v_and_b32 v54, v72, v10
  v_and_b32 v55, v72, v11
  ds_read_b128 a[208:211], v21 offset:25600
  s_waitcnt lgkmcnt(7)
  v_mfma_f32_16x16x32_bf16 v[44:47], a[212:215], v[52:55], v[44:47]
  v_and_b32 v56, v73, v8
  v_and_b32 v57, v73, v9
  v_and_b32 v58, v73, v10
  v_and_b32 v59, v73, v11
  ds_read_b128 a[212:215], v21 offset:26624
  s_waitcnt lgkmcnt(7)
  v_mfma_f32_16x16x32_bf16 v[44:47], a[216:219], v[56:59], v[44:47]
  v_and_b32 v52, v74, v8
  v_and_b32 v53, v74, v9
  v_and_b32 v54, v74, v10
  v_and_b32 v55, v74, v11
  ds_read_b128 a[216:219], v21 offset:27648
  s_waitcnt lgkmcnt(7)
  v_mfma_f32_16x16x32_bf16 v[48:51], a[220:223], v[52:55], v[48:51]
  v_and_b32 v56, v75, v8
  v_and_b32 v57, v75, v9
  v_and_b32 v58, v75, v10
  v_and_b32 v59, v75, v11
  ds_read_b128 a[220:223], v21 offset:28672
  s_waitcnt lgkmcnt(7)
  v_mfma_f32_16x16x32_bf16 v[48:51], a[224:227], v[56:59], v[48:51]
  v_and_b32 v52, v76, v8
  v_and_b32 v53, v76, v9
  v_and_b32 v54, v76, v10
  v_and_b32 v55, v76, v11
  ds_read_b128 a[224:227], v21 offset:29696
  s_waitcnt lgkmcnt(7)
  v_mfma_f32_16x16x32_bf16 v[48:51], a[228:231], v[52:55], v[48:51]
  v_and_b32 v56, v77, v8
  v_and_b32 v57, v77, v9
  v_and_b32 v58, v77, v10
  v_and_b32 v59, v77, v11
  s_nop 0
  s_waitcnt lgkmcnt(6)
  v_mfma_f32_16x16x32_bf16 v[48:51], a[232:235], v[56:59], v[48:51]
  v_and_b32 v52, v78, v8
  v_and_b32 v53, v78, v9
  v_and_b32 v54, v78, v10
  v_and_b32 v55, v78, v11
  s_nop 0
  s_waitcnt lgkmcnt(5)
  v_mfma_f32_16x16x32_bf16 v[48:51], a[204:207], v[52:55], v[48:51]
  v_and_b32 v56, v79, v8
  v_and_b32 v57, v79, v9
  v_and_b32 v58, v79, v10
  v_and_b32 v59, v79, v11
  s_nop 0
  s_waitcnt lgkmcnt(4)
  v_mfma_f32_16x16x32_bf16 v[48:51], a[208:211], v[56:59], v[48:51]
  s_mul_i32 s62, s59, 12288
  s_add_u32 s62, s62, s61
  buffer_load_dwordx4 v[184:187], v2, s[28:31], s62 offen offset:0 nt
  buffer_load_dwordx4 v[188:191], v2, s[28:31], s62 offen offset:256 nt
  buffer_load_dwordx4 v[192:195], v2, s[28:31], s62 offen offset:512 nt
  s_add_u32 s59, s59, 1
  s_and_b32 s59, s59, 63
  v_and_b32 v52, v80, v8
  v_and_b32 v53, v80, v9
  v_and_b32 v54, v80, v10
  v_and_b32 v55, v80, v11
  s_nop 0
  s_waitcnt lgkmcnt(3)
  v_mfma_f32_16x16x32_bf16 v[48:51], a[212:215], v[52:55], v[48:51]
  v_and_b32 v56, v81, v8
  v_and_b32 v57, v81, v9
  v_and_b32 v58, v81, v10
  v_and_b32 v59, v81, v11
  s_nop 0
  s_waitcnt lgkmcnt(2)
  v_mfma_f32_16x16x32_bf16 v[48:51], a[216:219], v[56:59], v[48:51]
  v_and_b32 v52, v82, v8
  v_and_b32 v53, v82, v9
  v_and_b32 v54, v82, v10
  v_and_b32 v55, v82, v11
  s_nop 0
  s_waitcnt lgkmcnt(1)
  v_mfma_f32_16x16x32_bf16 v[48:51], a[220:223], v[52:55], v[48:51]
  v_and_b32 v56, v83, v8
  v_and_b32 v57, v83, v9
  v_and_b32 v58, v83, v10
  v_and_b32 v59, v83, v11
  s_nop 0
  s_waitcnt lgkmcnt(0)
  v_mfma_f32_16x16x32_bf16 v[48:51], a[224:227], v[56:59], v[48:51]
  s_cmp_eq_u32 s49, 5
  s_cselect_b32 s4, 0, 1.0
  s_cselect_b32 s6, 1.0, 0
  s_cselect_b32 s5, 0, 1.0
  s_cselect_b32 s7, 0xffffff, 0
  s_cmp_eq_u32 s49, 2
  s_cselect_b32 s5, 0, s5
  s_cselect_b32 s7, 0xffffff, s7
  s_cmp_gt_u32 s49, 2
  s_addc_u32 s58, s49, 0
  s_cmp_gt_u32 s49, 5
  s_addc_u32 s58, s58, 0
  s_mul_i32 s58, s58, 384
  s_lshl_b32 s57, s54, 2
  s_add_u32 s50, s57, s52
  s_lshl_b32 s50, s50, 12
  s_add_u32 s58, s58, s50
  s_add_u32 s58, s58, 1048576
  s_add_u32 s50, s57, s53
  s_lshl_b32 s50, s50, 2
  s_add_u32 s50, s50, s52
  s_lshl_b32 s50, s50, 10
  s_add_u32 s50, s50, 1048576
  v_fmac_f32 v40, s4, v44
  v_fmac_f32 v41, s4, v45
  v_fmac_f32 v42, s4, v46
  v_fmac_f32 v43, s4, v47
  v_fmac_f32 v40, s5, v48
  v_fmac_f32 v41, s5, v49
  v_fmac_f32 v42, s5, v50
  v_fmac_f32 v43, s5, v51
  v_fmac_f32 v48, s6, v44
  v_fmac_f32 v49, s6, v45
  v_fmac_f32 v50, s6, v46
  v_fmac_f32 v51, s6, v47
  s_mov_b32 exec_lo, 0x00ff00ff
  s_mov_b32 exec_hi, 0xff00ff00
  ds_write_b128 v12, v[40:43] offset:10240
  ds_write_b128 v12, v[48:51] offset:10752
  s_mov_b64 exec, -1
  s_mul_i32 s57, s52, 1536
  v_and_b32 v21, 31, v1
  v_lshrrev_b32 v22, 5, v1
  v_mul_u32_u24 v4, 384, v22
  v_lshl_add_u32 v4, v21, 4, v4
  v_lshl_add_u32 v21, v21, 2, s57
  v_lshl_add_u32 v21, v22, 9, v21
  s_waitcnt lgkmcnt(0)
  ds_read_b32 v52, v21 offset:10240
  ds_read_b32 v53, v21 offset:10328
  ds_read_b32 v54, v21 offset:10416
  ds_read_b32 v55, v21 offset:10496
  ds_read_b32 v56, v21 offset:10584
  ds_read_b32 v57, v21 offset:10672
  v_mov_b32 v39, s48
  s_waitcnt lgkmcnt(0)
  v_add_f32 v36, v52, v55
  v_add_f32 v37, v53, v56
  v_add_f32 v38, v54, v57
  s_mov_b32 exec_lo, 0xffffff
  s_mov_b32 exec_hi, s7
  buffer_store_dwordx4 v[36:39], v4, s[44:47], s58 offen sc1 nt
  s_mov_b64 exec, -1
  s_cmp_eq_u32 s52, 3
  s_cselect_b32 s67, 0xffff, -1
  s_mul_i32 s62, s59, 12288
  s_add_u32 s62, s62, s61
  s_waitcnt vmcnt(5)
  buffer_load_dwordx4 v[196:199], v2, s[28:31], s62 offen offset:0 nt
  s_waitcnt vmcnt(5)
  buffer_load_dwordx4 v[200:203], v2, s[28:31], s62 offen offset:256 nt
  s_waitcnt vmcnt(5)
  buffer_load_dwordx4 v[204:207], v2, s[28:31], s62 offen offset:512 nt
  s_add_u32 s59, s59, 1
  s_and_b32 s59, s59, 63
  s_mul_i32 s62, s59, 12288
  s_add_u32 s62, s62, s61
  s_waitcnt vmcnt(5)
  buffer_load_dwordx4 v[208:211], v2, s[28:31], s62 offen offset:0 nt
  s_waitcnt vmcnt(5)
  buffer_load_dwordx4 v[212:215], v2, s[28:31], s62 offen offset:256 nt
  s_waitcnt vmcnt(5)
  buffer_load_dwordx4 v[216:219], v2, s[28:31], s62 offen offset:512 nt
  s_add_u32 s59, s59, 1
  s_and_b32 s59, s59, 63
  s_mul_i32 s62, s59, 12288
  s_add_u32 s62, s62, s61
  s_waitcnt vmcnt(5)
  buffer_load_dwordx4 v[220:223], v2, s[28:31], s62 offen offset:0 nt
  s_waitcnt vmcnt(5)
  buffer_load_dwordx4 v[224:227], v2, s[28:31], s62 offen offset:256 nt
  s_waitcnt vmcnt(5)
  buffer_load_dwordx4 v[228:231], v2, s[28:31], s62 offen offset:512 nt
  s_add_u32 s59, s59, 1
  s_and_b32 s59, s59, 63
  s_mov_b32 exec_hi, s67
  s_waitcnt vmcnt(5)
  buffer_load_dwordx4 v[52:55], v18, s[44:47], s50 offen sc1 nt
  s_mov_b64 exec, -1
  s_mul_i32 s62, s59, 12288
  s_add_u32 s62, s62, s61
  s_waitcnt vmcnt(5)
  buffer_load_dwordx4 v[232:235], v2, s[28:31], s62 offen offset:0 nt
  s_waitcnt vmcnt(5)
  buffer_load_dwordx4 v[236:239], v2, s[28:31], s62 offen offset:256 nt
  s_waitcnt vmcnt(5)
  buffer_load_dwordx4 v[240:243], v2, s[28:31], s62 offen offset:512 nt
  s_add_u32 s59, s59, 1
  s_and_b32 s59, s59, 63
  s_mul_i32 s62, s59, 12288
  s_add_u32 s62, s62, s61
  s_waitcnt vmcnt(5)
  buffer_load_dwordx4 a[0:3], v2, s[28:31], s62 offen offset:0 nt
  s_waitcnt vmcnt(5)
  buffer_load_dwordx4 a[4:7], v2, s[28:31], s62 offen offset:256 nt
  s_waitcnt vmcnt(5)
  buffer_load_dwordx4 a[8:11], v2, s[28:31], s62 offen offset:512 nt
  s_add_u32 s59, s59, 1
  s_and_b32 s59, s59, 63
  s_mul_i32 s62, s59, 12288
  s_add_u32 s62, s62, s61
  s_waitcnt vmcnt(5)
  buffer_load_dwordx4 a[12:15], v2, s[28:31], s62 offen offset:0 nt
  s_waitcnt vmcnt(5)
  buffer_load_dwordx4 a[16:19], v2, s[28:31], s62 offen offset:256 nt
  s_waitcnt vmcnt(5)
  buffer_load_dwordx4 a[20:23], v2, s[28:31], s62 offen offset:512 nt
  s_add_u32 s59, s59, 1
  s_and_b32 s59, s59, 63
  s_mul_i32 s62, s59, 12288
  s_add_u32 s62, s62, s61
  s_waitcnt vmcnt(5)
  buffer_load_dwordx4 a[24:27], v2, s[28:31], s62 offen offset:0 nt
  s_waitcnt vmcnt(5)
  buffer_load_dwordx4 a[28:31], v2, s[28:31], s62 offen offset:256 nt
  s_waitcnt vmcnt(5)
  buffer_load_dwordx4 a[32:35], v2, s[28:31], s62 offen offset:512 nt
  s_add_u32 s59, s59, 1
  s_and_b32 s59, s59, 63
  s_mul_i32 s62, s59, 12288
  s_add_u32 s62, s62, s61
  s_waitcnt vmcnt(5)
  buffer_load_dwordx4 a[36:39], v2, s[28:31], s62 offen offset:0 nt
  s_waitcnt vmcnt(5)
  buffer_load_dwordx4 a[40:43], v2, s[28:31], s62 offen offset:256 nt
  s_waitcnt vmcnt(5)
  buffer_load_dwordx4 a[44:47], v2, s[28:31], s62 offen offset:512 nt
  s_add_u32 s59, s59, 1
  s_and_b32 s59, s59, 63
  v_and_b32 v21, 32, v1
  v_and_b32 v22, 3, v1
  v_lshl_add_u32 v21, v22, 3, v21
  v_bfe_u32 v22, v1, 2, 3
  v_add_lshl_u32 v16, v21, v22, 1
  v_lshlrev_b32 v5, 4, v0
  v_mul_u32_u24 v21, 47, v1
  v_lshrrev_b32 v21, 10, v21
  v_mul_u32_u24 v22, 348, v21
  v_sub_u32 v4, v18, v22
  v_and_b32 v21, 3, v1
  v_lshl_add_u32 v21, v19, 2, v21
  v_and_b32 v22, 8, v1
  v_add_lshl_u32 v6, v21, v22, 4
  v_cmp_gt_u32 vcc, 8, v20
  v_add_u32 v22, 16, v21
  v_subrev_u32 v21, 8, v21
  v_cndmask_b32 v21, v21, v22, vcc
  v_lshlrev_b32 v21, 4, v21
  v_mov_b32 v24, 0
  v_mov_b32 v25, 0
  v_mov_b32 v26, 0
  v_mov_b32 v27, 0
  v_mov_b32 v28, 0
  v_mov_b32 v29, 0
  v_mov_b32 v30, 0
  v_mov_b32 v31, 0
  v_mov_b32 v32, 0
  v_mov_b32 v33, 0
  v_mov_b32 v34, 0
  v_mov_b32 v35, 0
  s_mov_b32 s68, 1048576
L_qchk:
  v_cmp_ne_u32 vcc, s48, v55
  s_nop 1
  s_and_b32 vcc_hi, vcc_hi, s67
  s_or_b32 vcc_lo, vcc_lo, vcc_hi
  s_cbranch_scc0 L_qok
  s_sub_u32 s68, s68, 1
  s_cmp_eq_u32 s68, 0
  s_cbranch_scc1 L_qok
  s_add_u32 s51, s51, 1
  s_sleep 2
  s_mov_b32 exec_hi, s67
  buffer_load_dwordx4 v[52:55], v18, s[44:47], s50 offen sc1 nt
  s_mov_b64 exec, -1
  s_waitcnt vmcnt(0)
  s_branch L_qchk
L_qok:
  ds_write_b128 v5, v[52:55] offset:55680
  s_waitcnt lgkmcnt(0)
  s_barrier
  ds_read_b32 v40, v4 offset:55680
  ds_read_b32 v43, v4 offset:56064
  ds_read_b32 v44, v4 offset:56448
  ds_read_b32 v41, v4 offset:56832
  ds_read_b32 v45, v4 offset:57216
  ds_read_b32 v46, v4 offset:57600
  ds_read_b32 v47, v4 offset:57984
  ds_read_b32 v42, v4 offset:58368
  ds_read_b32 v48, v4 offset:58752
  ds_read_b32 v49, v4 offset:59136
  s_waitcnt lgkmcnt(0)
  v_add_f32 v40, v40, v43
  v_add_f32 v41, v41, v45
  v_add_f32 v42, v42, v48
  v_add_f32 v46, v46, v47
  v_add_f32 v40, v40, v44
  v_add_f32 v42, v42, v49
  v_add_f32 v41, v41, v46
  v_cvt_pk_bf16_f32 v40, v40, v40
  v_cvt_pk_bf16_f32 v41, v41, v41
  v_cvt_pk_bf16_f32 v42, v42, v42
  ds_write_b16 v16, v40 offset:16384
  ds_write_b16 v16, v41 offset:16512
  ds_write_b16 v16, v42 offset:16640
  s_waitcnt lgkmcnt(0)
  s_mov_b32 exec_lo, 0x00ff00ff
  s_mov_b32 exec_hi, 0x00ff00ff
  ds_read_b128 v[24:27], v6 offset:16384
  s_mov_b32 exec_lo, 0xff00ff00
  s_mov_b32 exec_hi, 0xff00ff00
  ds_read_b128 v[32:35], v6 offset:16384
  s_mov_b32 exec_lo, 0x00ff00ff
  s_mov_b32 exec_hi, 0xff00ff00
  ds_read_b128 v[28:31], v21 offset:16384
  s_mov_b64 exec, -1
  v_mov_b32 v40, 0
  v_mov_b32 v41, 0
  v_mov_b32 v42, 0
  v_mov_b32 v43, 0
  v_mov_b32 v44, 0
  v_mov_b32 v45, 0
  v_mov_b32 v46, 0
  v_mov_b32 v47, 0
  v_mov_b32 v48, 0
  v_mov_b32 v49, 0
  v_mov_b32 v50, 0
  v_mov_b32 v51, 0
  s_waitcnt lgkmcnt(0)
  ds_read_b128 v[64:67], v94 offset:0
  ds_read_b128 v[68:71], v94 offset:16
  ds_read_b128 v[72:75], v94 offset:32
  ds_read_b128 v[76:79], v94 offset:48
  ds_read_b128 v[80:83], v94 offset:64
  ds_read_b128 v[84:87], v94 offset:80
  v_add_u32 v94, 96, v94
  s_lshl_b32 s69, s69, 16
  v_mfma_f32_16x16x32_bf16 v[36:39], v[100:103], v[24:27], 0
  v_mfma_f32_16x16x32_bf16 v[36:39], v[104:107], v[28:31], v[36:39]
  v_mfma_f32_16x16x32_bf16 v[36:39], v[108:111], v[32:35], v[36:39]
  s_mul_i32 s62, s59, 12288
  s_add_u32 s62, s62, s61
  buffer_load_dwordx4 v[100:103], v2, s[28:31], s62 offen offset:0 nt
  buffer_load_dwordx4 v[104:107], v2, s[28:31], s62 offen offset:256 nt
  s_waitcnt vmcnt(7)
  buffer_load_dwordx4 v[108:111], v2, s[28:31], s62 offen offset:512 nt
  s_add_u32 s59, s59, 1
  s_and_b32 s59, s59, 63
  s_add_u32 s62, s64, 20480
  s_waitcnt vmcnt(7)
  buffer_load_dwordx4 a[48:51], v7, s[40:43], s62 offen offset:256
  v_mov_b32_dpp v19, v36 quad_perm:[0,0,0,0] row_mask:0xf bank_mask:0xf
  v_mov_b32_dpp v20, v38 quad_perm:[2,2,2,2] row_mask:0xf bank_mask:0xf
  s_nop 0
  v_add_f32_dpp v19, v37, v19 quad_perm:[1,1,1,1] row_mask:0xf bank_mask:0xf
  v_add_f32_dpp v20, v39, v20 quad_perm:[3,3,3,3] row_mask:0xf bank_mask:0xf
  v_add_f32 v19, v19, v20
  v_cvt_pk_bf16_f32 v19, 0, v19
  v_mul_f32 v19, 0x3d93cd3a, v19
  v_cvt_pk_bf16_f32 v19, 0, v19
  v_max_f32 v17, v17, v19
  ds_write_b32 v15, v19 offset:0
  v_mfma_f32_16x16x32_bf16 v[36:39], v[112:115], v[24:27], 0
  v_mfma_f32_16x16x32_bf16 v[36:39], v[116:119], v[28:31], v[36:39]
  v_mfma_f32_16x16x32_bf16 v[36:39], v[120:123], v[32:35], v[36:39]
  s_mul_i32 s62, s59, 12288
  s_add_u32 s62, s62, s61
  s_waitcnt vmcnt(7)
  buffer_load_dwordx4 v[112:115], v2, s[28:31], s62 offen offset:0 nt
  s_waitcnt vmcnt(7)
  buffer_load_dwordx4 v[116:119], v2, s[28:31], s62 offen offset:256 nt
  s_waitcnt vmcnt(7)
  buffer_load_dwordx4 v[120:123], v2, s[28:31], s62 offen offset:512 nt
  s_add_u32 s59, s59, 1
  s_and_b32 s59, s59, 63
  s_add_u32 s62, s64, 30720
  s_waitcnt vmcnt(7)
  buffer_load_dwordx4 a[52:55], v7, s[40:43], s62 offen offset:256
  v_mov_b32_dpp v19, v36 quad_perm:[0,0,0,0] row_mask:0xf bank_mask:0xf
  v_mov_b32_dpp v20, v38 quad_perm:[2,2,2,2] row_mask:0xf bank_mask:0xf
  s_nop 0
  v_add_f32_dpp v19, v37, v19 quad_perm:[1,1,1,1] row_mask:0xf bank_mask:0xf
  v_add_f32_dpp v20, v39, v20 quad_perm:[3,3,3,3] row_mask:0xf bank_mask:0xf
  v_add_f32 v19, v19, v20
  v_cvt_pk_bf16_f32 v19, 0, v19
  v_mul_f32 v19, 0x3d93cd3a, v19
  v_cvt_pk_bf16_f32 v19, 0, v19
  v_max_f32 v17, v17, v19
  ds_write_b32 v15, v19 offset:32
  v_mfma_f32_16x16x32_bf16 v[36:39], v[124:127], v[24:27], 0
  v_mfma_f32_16x16x32_bf16 v[36:39], v[128:131], v[28:31], v[36:39]
  v_mfma_f32_16x16x32_bf16 v[36:39], v[132:135], v[32:35], v[36:39]
  s_mul_i32 s62, s59, 12288
  s_add_u32 s62, s62, s61
  s_waitcnt vmcnt(7)
  buffer_load_dwordx4 v[124:127], v2, s[28:31], s62 offen offset:0 nt
  s_waitcnt vmcnt(7)
  buffer_load_dwordx4 v[128:131], v2, s[28:31], s62 offen offset:256 nt
  s_waitcnt vmcnt(7)
  buffer_load_dwordx4 v[132:135], v2, s[28:31], s62 offen offset:512 nt
  s_add_u32 s59, s59, 1
  s_and_b32 s59, s59, 63
  s_add_u32 s62, s64, 20480
  s_waitcnt vmcnt(7)
  buffer_load_dwordx4 a[56:59], v7, s[40:43], s62 offen offset:512
  v_mov_b32_dpp v19, v36 quad_perm:[0,0,0,0] row_mask:0xf bank_mask:0xf
  v_mov_b32_dpp v20, v38 quad_perm:[2,2,2,2] row_mask:0xf bank_mask:0xf
  s_nop 0
  v_add_f32_dpp v19, v37, v19 quad_perm:[1,1,1,1] row_mask:0xf bank_mask:0xf
  v_add_f32_dpp v20, v39, v20 quad_perm:[3,3,3,3] row_mask:0xf bank_mask:0xf
  v_add_f32 v19, v19, v20
  v_cvt_pk_bf16_f32 v19, 0, v19
  v_mul_f32 v19, 0x3d93cd3a, v19
  v_cvt_pk_bf16_f32 v19, 0, v19
  v_max_f32 v17, v17, v19
  ds_write_b32 v15, v19 offset:64
  v_mfma_f32_16x16x32_bf16 v[36:39], v[136:139], v[24:27], 0
  v_mfma_f32_16x16x32_bf16 v[36:39], v[140:143], v[28:31], v[36:39]
  v_mfma_f32_16x16x32_bf16 v[36:39], v[144:147], v[32:35], v[36:39]
  s_mul_i32 s62, s59, 12288
  s_add_u32 s62, s62, s61
  s_waitcnt vmcnt(7)
  buffer_load_dwordx4 v[136:139], v2, s[28:31], s62 offen offset:0 nt
  s_waitcnt vmcnt(7)
  buffer_load_dwordx4 v[140:143], v2, s[28:31], s62 offen offset:256 nt
  s_waitcnt vmcnt(7)
  buffer_load_dwordx4 v[144:147], v2, s[28:31], s62 offen offset:512 nt
  s_add_u32 s59, s59, 1
  s_and_b32 s59, s59, 63
  s_add_u32 s62, s64, 30720
  s_waitcnt vmcnt(7)
  buffer_load_dwordx4 a[60:63], v7, s[40:43], s62 offen offset:512
  v_mov_b32_dpp v19, v36 quad_perm:[0,0,0,0] row_mask:0xf bank_mask:0xf
  v_mov_b32_dpp v20, v38 quad_perm:[2,2,2,2] row_mask:0xf bank_mask:0xf
  s_nop 0
  v_add_f32_dpp v19, v37, v19 quad_perm:[1,1,1,1] row_mask:0xf bank_mask:0xf
  v_add_f32_dpp v20, v39, v20 quad_perm:[3,3,3,3] row_mask:0xf bank_mask:0xf
  v_add_f32 v19, v19, v20
  v_cvt_pk_bf16_f32 v19, 0, v19
  v_mul_f32 v19, 0x3d93cd3a, v19
  v_cvt_pk_bf16_f32 v19, 0, v19
  v_max_f32 v17, v17, v19
  ds_write_b32 v15, v19 offset:96
  v_mfma_f32_16x16x32_bf16 v[36:39], v[148:151], v[24:27], 0
  v_mfma_f32_16x16x32_bf16 v[36:39], v[152:155], v[28:31], v[36:39]
  v_mfma_f32_16x16x32_bf16 v[36:39], v[156:159], v[32:35], v[36:39]
  s_mul_i32 s62, s59, 12288
  s_add_u32 s62, s62, s61
  s_waitcnt vmcnt(7)
  buffer_load_dwordx4 v[148:151], v2, s[28:31], s62 offen offset:0 nt
  s_waitcnt vmcnt(7)
  buffer_load_dwordx4 v[152:155], v2, s[28:31], s62 offen offset:256 nt
  s_waitcnt vmcnt(7)
  buffer_load_dwordx4 v[156:159], v2, s[28:31], s62 offen offset:512 nt
  s_add_u32 s59, s59, 1
  s_and_b32 s59, s59, 63
  s_add_u32 s62, s64, 20480
  s_waitcnt vmcnt(7)
  buffer_load_dwordx4 a[64:67], v7, s[40:43], s62 offen offset:768
  v_mov_b32_dpp v19, v36 quad_perm:[0,0,0,0] row_mask:0xf bank_mask:0xf
  v_mov_b32_dpp v20, v38 quad_perm:[2,2,2,2] row_mask:0xf bank_mask:0xf
  s_nop 0
  v_add_f32_dpp v19, v37, v19 quad_perm:[1,1,1,1] row_mask:0xf bank_mask:0xf
  v_add_f32_dpp v20, v39, v20 quad_perm:[3,3,3,3] row_mask:0xf bank_mask:0xf
  v_add_f32 v19, v19, v20
  v_cvt_pk_bf16_f32 v19, 0, v19
  v_mul_f32 v19, 0x3d93cd3a, v19
  v_cvt_pk_bf16_f32 v19, 0, v19
  v_max_f32 v17, v17, v19
  ds_write_b32 v15, v19 offset:128
  v_mfma_f32_16x16x32_bf16 v[36:39], v[160:163], v[24:27], 0
  v_mfma_f32_16x16x32_bf16 v[36:39], v[164:167], v[28:31], v[36:39]
  v_mfma_f32_16x16x32_bf16 v[36:39], v[168:171], v[32:35], v[36:39]
  s_mul_i32 s62, s59, 12288
  s_add_u32 s62, s62, s61
  s_waitcnt vmcnt(7)
  buffer_load_dwordx4 v[160:163], v2, s[28:31], s62 offen offset:0 nt
  s_waitcnt vmcnt(7)
  buffer_load_dwordx4 v[164:167], v2, s[28:31], s62 offen offset:256 nt
  s_waitcnt vmcnt(7)
  buffer_load_dwordx4 v[168:171], v2, s[28:31], s62 offen offset:512 nt
  s_add_u32 s59, s59, 1
  s_and_b32 s59, s59, 63
  s_add_u32 s62, s64, 30720
  s_waitcnt vmcnt(7)
  buffer_load_dwordx4 a[68:71], v7, s[40:43], s62 offen offset:768
  v_mov_b32_dpp v19, v36 quad_perm:[0,0,0,0] row_mask:0xf bank_mask:0xf
  v_mov_b32_dpp v20, v38 quad_perm:[2,2,2,2] row_mask:0xf bank_mask:0xf
  s_nop 0
  v_add_f32_dpp v19, v37, v19 quad_perm:[1,1,1,1] row_mask:0xf bank_mask:0xf
  v_add_f32_dpp v20, v39, v20 quad_perm:[3,3,3,3] row_mask:0xf bank_mask:0xf
  v_add_f32 v19, v19, v20
  v_cvt_pk_bf16_f32 v19, 0, v19
  v_mul_f32 v19, 0x3d93cd3a, v19
  v_cvt_pk_bf16_f32 v19, 0, v19
  v_max_f32 v17, v17, v19
  ds_write_b32 v15, v19 offset:160
  v_mfma_f32_16x16x32_bf16 v[36:39], v[172:175], v[24:27], 0
  v_mfma_f32_16x16x32_bf16 v[36:39], v[176:179], v[28:31], v[36:39]
  v_mfma_f32_16x16x32_bf16 v[36:39], v[180:183], v[32:35], v[36:39]
  s_mul_i32 s62, s59, 12288
  s_add_u32 s62, s62, s61
  s_waitcnt vmcnt(7)
  buffer_load_dwordx4 v[172:175], v2, s[28:31], s62 offen offset:0 nt
  s_waitcnt vmcnt(7)
  buffer_load_dwordx4 v[176:179], v2, s[28:31], s62 offen offset:256 nt
  s_waitcnt vmcnt(7)
  buffer_load_dwordx4 v[180:183], v2, s[28:31], s62 offen offset:512 nt
  s_add_u32 s59, s59, 1
  s_and_b32 s59, s59, 63
  s_add_u32 s62, s64, 20480
  s_waitcnt vmcnt(7)
  buffer_load_dwordx4 a[72:75], v7, s[40:43], s62 offen offset:1024
  v_mov_b32_dpp v19, v36 quad_perm:[0,0,0,0] row_mask:0xf bank_mask:0xf
  v_mov_b32_dpp v20, v38 quad_perm:[2,2,2,2] row_mask:0xf bank_mask:0xf
  s_nop 0
  v_add_f32_dpp v19, v37, v19 quad_perm:[1,1,1,1] row_mask:0xf bank_mask:0xf
  v_add_f32_dpp v20, v39, v20 quad_perm:[3,3,3,3] row_mask:0xf bank_mask:0xf
  v_add_f32 v19, v19, v20
  v_cvt_pk_bf16_f32 v19, 0, v19
  v_mul_f32 v19, 0x3d93cd3a, v19
  v_cvt_pk_bf16_f32 v19, 0, v19
  v_max_f32 v17, v17, v19
  ds_write_b32 v15, v19 offset:192
  v_mfma_f32_16x16x32_bf16 v[36:39], v[184:187], v[24:27], 0
  v_mfma_f32_16x16x32_bf16 v[36:39], v[188:191], v[28:31], v[36:39]
  v_mfma_f32_16x16x32_bf16 v[36:39], v[192:195], v[32:35], v[36:39]
  s_mul_i32 s62, s59, 12288
  s_add_u32 s62, s62, s61
  s_waitcnt vmcnt(7)
  buffer_load_dwordx4 v[184:187], v2, s[28:31], s62 offen offset:0 nt
  s_waitcnt vmcnt(7)
  buffer_load_dwordx4 v[188:191], v2, s[28:31], s62 offen offset:256 nt
  s_waitcnt vmcnt(7)
  buffer_load_dwordx4 v[192:195], v2, s[28:31], s62 offen offset:512 nt
  s_add_u32 s59, s59, 1
  s_and_b32 s59, s59, 63
  s_add_u32 s62, s64, 30720
  s_waitcnt vmcnt(7)
  buffer_load_dwordx4 a[76:79], v7, s[40:43], s62 offen offset:1024
  v_mov_b32_dpp v19, v36 quad_perm:[0,0,0,0] row_mask:0xf bank_mask:0xf
  v_mov_b32_dpp v20, v38 quad_perm:[2,2,2,2] row_mask:0xf bank_mask:0xf
  s_nop 0
  v_add_f32_dpp v19, v37, v19 quad_perm:[1,1,1,1] row_mask:0xf bank_mask:0xf
  v_add_f32_dpp v20, v39, v20 quad_perm:[3,3,3,3] row_mask:0xf bank_mask:0xf
  v_add_f32 v19, v19, v20
  v_cvt_pk_bf16_f32 v19, 0, v19
  v_mul_f32 v19, 0x3d93cd3a, v19
  v_cvt_pk_bf16_f32 v19, 0, v19
  v_max_f32 v17, v17, v19
  ds_write_b32 v15, v19 offset:224
  v_mfma_f32_16x16x32_bf16 v[36:39], v[196:199], v[24:27], 0
  v_mfma_f32_16x16x32_bf16 v[36:39], v[200:203], v[28:31], v[36:39]
  v_mfma_f32_16x16x32_bf16 v[36:39], v[204:207], v[32:35], v[36:39]
  s_mul_i32 s62, s59, 12288
  s_add_u32 s62, s62, s61
  s_waitcnt vmcnt(7)
  buffer_load_dwordx4 v[196:199], v2, s[28:31], s62 offen offset:0 nt
  s_waitcnt vmcnt(7)
  buffer_load_dwordx4 v[200:203], v2, s[28:31], s62 offen offset:256 nt
  s_waitcnt vmcnt(7)
  buffer_load_dwordx4 v[204:207], v2, s[28:31], s62 offen offset:512 nt
  s_add_u32 s59, s59, 1
  s_and_b32 s59, s59, 63
  s_add_u32 s62, s64, 40960
  s_waitcnt vmcnt(7)
  buffer_load_dwordx4 a[80:83], v7, s[40:43], s62 offen offset:0
  v_mov_b32_dpp v19, v36 quad_perm:[0,0,0,0] row_mask:0xf bank_mask:0xf
  v_mov_b32_dpp v20, v38 quad_perm:[2,2,2,2] row_mask:0xf bank_mask:0xf
  s_nop 0
  v_add_f32_dpp v19, v37, v19 quad_perm:[1,1,1,1] row_mask:0xf bank_mask:0xf
  v_add_f32_dpp v20, v39, v20 quad_perm:[3,3,3,3] row_mask:0xf bank_mask:0xf
  v_add_f32 v19, v19, v20
  v_cvt_pk_bf16_f32 v19, 0, v19
  v_mul_f32 v19, 0x3d93cd3a, v19
  v_cvt_pk_bf16_f32 v19, 0, v19
  v_max_f32 v17, v17, v19
  ds_write_b32 v15, v19 offset:256
  v_mfma_f32_16x16x32_bf16 v[36:39], v[208:211], v[24:27], 0
  v_mfma_f32_16x16x32_bf16 v[36:39], v[212:215], v[28:31], v[36:39]
  v_mfma_f32_16x16x32_bf16 v[36:39], v[216:219], v[32:35], v[36:39]
  s_mul_i32 s62, s59, 12288
  s_add_u32 s62, s62, s61
  s_waitcnt vmcnt(7)
  buffer_load_dwordx4 v[208:211], v2, s[28:31], s62 offen offset:0 nt
  s_waitcnt vmcnt(7)
  buffer_load_dwordx4 v[212:215], v2, s[28:31], s62 offen offset:256 nt
  s_waitcnt vmcnt(7)
  buffer_load_dwordx4 v[216:219], v2, s[28:31], s62 offen offset:512 nt
  s_add_u32 s59, s59, 1
  s_and_b32 s59, s59, 63
  s_add_u32 s62, s64, 51200
  s_waitcnt vmcnt(7)
  buffer_load_dwordx4 a[84:87], v7, s[40:43], s62 offen offset:0
  v_mov_b32_dpp v19, v36 quad_perm:[0,0,0,0] row_mask:0xf bank_mask:0xf
  v_mov_b32_dpp v20, v38 quad_perm:[2,2,2,2] row_mask:0xf bank_mask:0xf
  s_nop 0
  v_add_f32_dpp v19, v37, v19 quad_perm:[1,1,1,1] row_mask:0xf bank_mask:0xf
  v_add_f32_dpp v20, v39, v20 quad_perm:[3,3,3,3] row_mask:0xf bank_mask:0xf
  v_add_f32 v19, v19, v20
  v_cvt_pk_bf16_f32 v19, 0, v19
  v_mul_f32 v19, 0x3d93cd3a, v19
  v_cvt_pk_bf16_f32 v19, 0, v19
  v_max_f32 v17, v17, v19
  ds_write_b32 v15, v19 offset:288
  v_mfma_f32_16x16x32_bf16 v[36:39], v[220:223], v[24:27], 0
  v_mfma_f32_16x16x32_bf16 v[36:39], v[224:227], v[28:31], v[36:39]
  v_mfma_f32_16x16x32_bf16 v[36:39], v[228:231], v[32:35], v[36:39]
  s_mul_i32 s62, s59, 12288
  s_add_u32 s62, s62, s61
  s_waitcnt vmcnt(7)
  buffer_load_dwordx4 v[220:223], v2, s[28:31], s62 offen offset:0 nt
  s_waitcnt vmcnt(7)
  buffer_load_dwordx4 v[224:227], v2, s[28:31], s62 offen offset:256 nt
  s_waitcnt vmcnt(7)
  buffer_load_dwordx4 v[228:231], v2, s[28:31], s62 offen offset:512 nt
  s_add_u32 s59, s59, 1
  s_and_b32 s59, s59, 63
  s_add_u32 s62, s64, 40960
  s_waitcnt vmcnt(7)
  buffer_load_dwordx4 a[88:91], v7, s[40:43], s62 offen offset:256
  v_mov_b32_dpp v19, v36 quad_perm:[0,0,0,0] row_mask:0xf bank_mask:0xf
  v_mov_b32_dpp v20, v38 quad_perm:[2,2,2,2] row_mask:0xf bank_mask:0xf
  s_nop 0
  v_add_f32_dpp v19, v37, v19 quad_perm:[1,1,1,1] row_mask:0xf bank_mask:0xf
  v_add_f32_dpp v20, v39, v20 quad_perm:[3,3,3,3] row_mask:0xf bank_mask:0xf
  v_add_f32 v19, v19, v20
  v_cvt_pk_bf16_f32 v19, 0, v19
  v_mul_f32 v19, 0x3d93cd3a, v19
  v_cvt_pk_bf16_f32 v19, 0, v19
  v_max_f32 v17, v17, v19
  ds_write_b32 v15, v19 offset:320
  v_mfma_f32_16x16x32_bf16 v[36:39], v[232:235], v[24:27], 0
  v_mfma_f32_16x16x32_bf16 v[36:39], v[236:239], v[28:31], v[36:39]
  v_mfma_f32_16x16x32_bf16 v[36:39], v[240:243], v[32:35], v[36:39]
  s_mul_i32 s62, s59, 12288
  s_add_u32 s62, s62, s61
  s_waitcnt vmcnt(7)
  buffer_load_dwordx4 v[232:235], v2, s[28:31], s62 offen offset:0 nt
  s_waitcnt vmcnt(7)
  buffer_load_dwordx4 v[236:239], v2, s[28:31], s62 offen offset:256 nt
  s_waitcnt vmcnt(7)
  buffer_load_dwordx4 v[240:243], v2, s[28:31], s62 offen offset:512 nt
  s_add_u32 s59, s59, 1
  s_and_b32 s59, s59, 63
  s_add_u32 s62, s64, 51200
  s_waitcnt vmcnt(7)
  buffer_load_dwordx4 a[92:95], v7, s[40:43], s62 offen offset:256
  v_mov_b32_dpp v19, v36 quad_perm:[0,0,0,0] row_mask:0xf bank_mask:0xf
  v_mov_b32_dpp v20, v38 quad_perm:[2,2,2,2] row_mask:0xf bank_mask:0xf
  s_nop 0
  v_add_f32_dpp v19, v37, v19 quad_perm:[1,1,1,1] row_mask:0xf bank_mask:0xf
  v_add_f32_dpp v20, v39, v20 quad_perm:[3,3,3,3] row_mask:0xf bank_mask:0xf
  v_add_f32 v19, v19, v20
  v_cvt_pk_bf16_f32 v19, 0, v19
  v_mul_f32 v19, 0x3d93cd3a, v19
  v_cvt_pk_bf16_f32 v19, 0, v19
  v_max_f32 v17, v17, v19
  ds_write_b32 v15, v19 offset:352
  v_mfma_f32_16x16x32_bf16 v[36:39], a[0:3], v[24:27], 0
  v_mfma_f32_16x16x32_bf16 v[36:39], a[4:7], v[28:31], v[36:39]
  v_mfma_f32_16x16x32_bf16 v[36:39], a[8:11], v[32:35], v[36:39]
  s_nop 6
  s_add_u32 s62, s64, 40960
  s_waitcnt vmcnt(7)
  buffer_load_dwordx4 a[96:99], v7, s[40:43], s62 offen offset:512
  v_mov_b32_dpp v19, v36 quad_perm:[0,0,0,0] row_mask:0xf bank_mask:0xf
  v_mov_b32_dpp v20, v38 quad_perm:[2,2,2,2] row_mask:0xf bank_mask:0xf
  s_nop 0
  v_add_f32_dpp v19, v37, v19 quad_perm:[1,1,1,1] row_mask:0xf bank_mask:0xf
  v_add_f32_dpp v20, v39, v20 quad_perm:[3,3,3,3] row_mask:0xf bank_mask:0xf
  v_add_f32 v19, v19, v20
  v_cvt_pk_bf16_f32 v19, 0, v19
  v_mul_f32 v19, 0x3d93cd3a, v19
  v_cvt_pk_bf16_f32 v19, 0, v19
  v_max_f32 v17, v17, v19
  ds_write_b32 v15, v19 offset:384
  v_mfma_f32_16x16x32_bf16 v[36:39], a[12:15], v[24:27], 0
  v_mfma_f32_16x16x32_bf16 v[36:39], a[16:19], v[28:31], v[36:39]
  v_mfma_f32_16x16x32_bf16 v[36:39], a[20:23], v[32:35], v[36:39]
  s_nop 6
  s_add_u32 s62, s64, 51200
  s_waitcnt vmcnt(7)
  buffer_load_dwordx4 a[100:103], v7, s[40:43], s62 offen offset:512
  v_mov_b32_dpp v19, v36 quad_perm:[0,0,0,0] row_mask:0xf bank_mask:0xf
  v_mov_b32_dpp v20, v38 quad_perm:[2,2,2,2] row_mask:0xf bank_mask:0xf
  s_nop 0
  v_add_f32_dpp v19, v37, v19 quad_perm:[1,1,1,1] row_mask:0xf bank_mask:0xf
  v_add_f32_dpp v20, v39, v20 quad_perm:[3,3,3,3] row_mask:0xf bank_mask:0xf
  v_add_f32 v19, v19, v20
  v_cvt_pk_bf16_f32 v19, 0, v19
  v_mul_f32 v19, 0x3d93cd3a, v19
  v_cvt_pk_bf16_f32 v19, 0, v19
  v_max_f32 v17, v17, v19
  ds_write_b32 v15, v19 offset:416
  v_mfma_f32_16x16x32_bf16 v[36:39], a[24:27], v[24:27], 0
  v_mfma_f32_16x16x32_bf16 v[36:39], a[28:31], v[28:31], v[36:39]
  v_mfma_f32_16x16x32_bf16 v[36:39], a[32:35], v[32:35], v[36:39]
  s_nop 6
  s_add_u32 s62, s64, 40960
  s_waitcnt vmcnt(7)
  buffer_load_dwordx4 a[104:107], v7, s[40:43], s62 offen offset:768
  v_mov_b32_dpp v19, v36 quad_perm:[0,0,0,0] row_mask:0xf bank_mask:0xf
  v_mov_b32_dpp v20, v38 quad_perm:[2,2,2,2] row_mask:0xf bank_mask:0xf
  s_nop 0
  v_add_f32_dpp v19, v37, v19 quad_perm:[1,1,1,1] row_mask:0xf bank_mask:0xf
  v_add_f32_dpp v20, v39, v20 quad_perm:[3,3,3,3] row_mask:0xf bank_mask:0xf
  v_add_f32 v19, v19, v20
  v_cvt_pk_bf16_f32 v19, 0, v19
  v_mul_f32 v19, 0x3d93cd3a, v19
  v_cvt_pk_bf16_f32 v19, 0, v19
  v_max_f32 v17, v17, v19
  ds_write_b32 v15, v19 offset:448
  v_mfma_f32_16x16x32_bf16 v[36:39], a[36:39], v[24:27], 0
  v_mfma_f32_16x16x32_bf16 v[36:39], a[40:43], v[28:31], v[36:39]
  v_mfma_f32_16x16x32_bf16 v[36:39], a[44:47], v[32:35], v[36:39]
  s_nop 6
  s_add_u32 s62, s64, 51200
  s_waitcnt vmcnt(7)
  buffer_load_dwordx4 a[108:111], v7, s[40:43], s62 offen offset:768
  v_mov_b32_dpp v19, v36 quad_perm:[0,0,0,0] row_mask:0xf bank_mask:0xf
  v_mov_b32_dpp v20, v38 quad_perm:[2,2,2,2] row_mask:0xf bank_mask:0xf
  s_nop 0
  v_add_f32_dpp v19, v37, v19 quad_perm:[1,1,1,1] row_mask:0xf bank_mask:0xf
  v_add_f32_dpp v20, v39, v20 quad_perm:[3,3,3,3] row_mask:0xf bank_mask:0xf
  v_add_f32 v19, v19, v20
  v_cvt_pk_bf16_f32 v19, 0, v19
  v_mul_f32 v19, 0x3d93cd3a, v19
  v_cvt_pk_bf16_f32 v19, 0, v19
  v_max_f32 v17, v17, v19
  ds_write_b32 v15, v19 offset:480
  v_mfma_f32_16x16x32_bf16 v[36:39], v[100:103], v[24:27], 0
  v_mfma_f32_16x16x32_bf16 v[36:39], v[104:107], v[28:31], v[36:39]
  v_mfma_f32_16x16x32_bf16 v[36:39], v[108:111], v[32:35], v[36:39]
  s_mul_i32 s62, s59, 12288
  s_add_u32 s62, s62, s61
  s_waitcnt vmcnt(7)
  buffer_load_dwordx4 v[100:103], v2, s[28:31], s62 offen offset:0 nt
  s_waitcnt vmcnt(7)
  buffer_load_dwordx4 v[104:107], v2, s[28:31], s62 offen offset:256 nt
  s_waitcnt vmcnt(7)
  buffer_load_dwordx4 v[108:111], v2, s[28:31], s62 offen offset:512 nt
  s_add_u32 s59, s59, 1
  s_and_b32 s59, s59, 63
  s_add_u32 s62, s64, 40960
  s_waitcnt vmcnt(7)
  buffer_load_dwordx4 a[112:115], v7, s[40:43], s62 offen offset:1024
  v_mov_b32_dpp v19, v36 quad_perm:[0,0,0,0] row_mask:0xf bank_mask:0xf
  v_mov_b32_dpp v20, v38 quad_perm:[2,2,2,2] row_mask:0xf bank_mask:0xf
  s_nop 0
  v_add_f32_dpp v19, v37, v19 quad_perm:[1,1,1,1] row_mask:0xf bank_mask:0xf
  v_add_f32_dpp v20, v39, v20 quad_perm:[3,3,3,3] row_mask:0xf bank_mask:0xf
  v_add_f32 v19, v19, v20
  v_cvt_pk_bf16_f32 v19, 0, v19
  v_mul_f32 v19, 0x3d93cd3a, v19
  v_cvt_pk_bf16_f32 v19, 0, v19
  v_max_f32 v17, v17, v19
  ds_write_b32 v15, v19 offset:512
  v_mfma_f32_16x16x32_bf16 v[36:39], v[112:115], v[24:27], 0
  v_mfma_f32_16x16x32_bf16 v[36:39], v[116:119], v[28:31], v[36:39]
  v_mfma_f32_16x16x32_bf16 v[36:39], v[120:123], v[32:35], v[36:39]
  s_mul_i32 s62, s59, 12288
  s_add_u32 s62, s62, s61
  s_waitcnt vmcnt(7)
  buffer_load_dwordx4 v[112:115], v2, s[28:31], s62 offen offset:0 nt
  s_waitcnt vmcnt(7)
  buffer_load_dwordx4 v[116:119], v2, s[28:31], s62 offen offset:256 nt
  s_waitcnt vmcnt(7)
  buffer_load_dwordx4 v[120:123], v2, s[28:31], s62 offen offset:512 nt
  s_add_u32 s59, s59, 1
  s_and_b32 s59, s59, 63
  s_add_u32 s62, s64, 51200
  s_waitcnt vmcnt(7)
  buffer_load_dwordx4 a[116:119], v7, s[40:43], s62 offen offset:1024
  v_mov_b32_dpp v19, v36 quad_perm:[0,0,0,0] row_mask:0xf bank_mask:0xf
  v_mov_b32_dpp v20, v38 quad_perm:[2,2,2,2] row_mask:0xf bank_mask:0xf
  s_nop 0
  v_add_f32_dpp v19, v37, v19 quad_perm:[1,1,1,1] row_mask:0xf bank_mask:0xf
  v_add_f32_dpp v20, v39, v20 quad_perm:[3,3,3,3] row_mask:0xf bank_mask:0xf
  v_add_f32 v19, v19, v20
  v_cvt_pk_bf16_f32 v19, 0, v19
  v_mul_f32 v19, 0x3d93cd3a, v19
  v_cvt_pk_bf16_f32 v19, 0, v19
  v_max_f32 v17, v17, v19
  ds_write_b32 v15, v19 offset:544
  v_mfma_f32_16x16x32_bf16 v[36:39], v[124:127], v[24:27], 0
  v_mfma_f32_16x16x32_bf16 v[36:39], v[128:131], v[28:31], v[36:39]
  v_mfma_f32_16x16x32_bf16 v[36:39], v[132:135], v[32:35], v[36:39]
  s_mul_i32 s62, s59, 12288
  s_add_u32 s62, s62, s61
  s_waitcnt vmcnt(7)
  buffer_load_dwordx4 v[124:127], v2, s[28:31], s62 offen offset:0 nt
  s_waitcnt vmcnt(7)
  buffer_load_dwordx4 v[128:131], v2, s[28:31], s62 offen offset:256 nt
  s_waitcnt vmcnt(7)
  buffer_load_dwordx4 v[132:135], v2, s[28:31], s62 offen offset:512 nt
  s_add_u32 s59, s59, 1
  s_and_b32 s59, s59, 63
  s_add_u32 s62, s64, 61440
  s_waitcnt vmcnt(7)
  buffer_load_dwordx4 a[120:123], v7, s[40:43], s62 offen offset:0
  v_mov_b32_dpp v19, v36 quad_perm:[0,0,0,0] row_mask:0xf bank_mask:0xf
  v_mov_b32_dpp v20, v38 quad_perm:[2,2,2,2] row_mask:0xf bank_mask:0xf
  s_nop 0
  v_add_f32_dpp v19, v37, v19 quad_perm:[1,1,1,1] row_mask:0xf bank_mask:0xf
  v_add_f32_dpp v20, v39, v20 quad_perm:[3,3,3,3] row_mask:0xf bank_mask:0xf
  v_add_f32 v19, v19, v20
  v_cvt_pk_bf16_f32 v19, 0, v19
  v_mul_f32 v19, 0x3d93cd3a, v19
  v_cvt_pk_bf16_f32 v19, 0, v19
  v_max_f32 v17, v17, v19
  ds_write_b32 v15, v19 offset:576
  v_mfma_f32_16x16x32_bf16 v[36:39], v[136:139], v[24:27], 0
  v_mfma_f32_16x16x32_bf16 v[36:39], v[140:143], v[28:31], v[36:39]
  v_mfma_f32_16x16x32_bf16 v[36:39], v[144:147], v[32:35], v[36:39]
  s_mul_i32 s62, s59, 12288
  s_add_u32 s62, s62, s61
  s_waitcnt vmcnt(7)
  buffer_load_dwordx4 v[136:139], v2, s[28:31], s62 offen offset:0 nt
  s_waitcnt vmcnt(7)
  buffer_load_dwordx4 v[140:143], v2, s[28:31], s62 offen offset:256 nt
  s_waitcnt vmcnt(7)
  buffer_load_dwordx4 v[144:147], v2, s[28:31], s62 offen offset:512 nt
  s_add_u32 s59, s59, 1
  s_and_b32 s59, s59, 63
  s_add_u32 s62, s64, 71680
  s_waitcnt vmcnt(7)
  buffer_load_dwordx4 a[124:127], v7, s[40:43], s62 offen offset:0
  v_mov_b32_dpp v19, v36 quad_perm:[0,0,0,0] row_mask:0xf bank_mask:0xf
  v_mov_b32_dpp v20, v38 quad_perm:[2,2,2,2] row_mask:0xf bank_mask:0xf
  s_nop 0
  v_add_f32_dpp v19, v37, v19 quad_perm:[1,1,1,1] row_mask:0xf bank_mask:0xf
  v_add_f32_dpp v20, v39, v20 quad_perm:[3,3,3,3] row_mask:0xf bank_mask:0xf
  v_add_f32 v19, v19, v20
  v_cvt_pk_bf16_f32 v19, 0, v19
  v_mul_f32 v19, 0x3d93cd3a, v19
  v_cvt_pk_bf16_f32 v19, 0, v19
  v_max_f32 v17, v17, v19
  ds_write_b32 v15, v19 offset:608
  v_mfma_f32_16x16x32_bf16 v[36:39], v[148:151], v[24:27], 0
  v_mfma_f32_16x16x32_bf16 v[36:39], v[152:155], v[28:31], v[36:39]
  v_mfma_f32_16x16x32_bf16 v[36:39], v[156:159], v[32:35], v[36:39]
  s_mul_i32 s62, s59, 12288
  s_add_u32 s62, s62, s61
  s_waitcnt vmcnt(7)
  buffer_load_dwordx4 v[148:151], v2, s[28:31], s62 offen offset:0 nt
  s_waitcnt vmcnt(7)
  buffer_load_dwordx4 v[152:155], v2, s[28:31], s62 offen offset:256 nt
  s_waitcnt vmcnt(7)
  buffer_load_dwordx4 v[156:159], v2, s[28:31], s62 offen offset:512 nt
  s_add_u32 s59, s59, 1
  s_and_b32 s59, s59, 63
  s_add_u32 s62, s64, 61440
  s_waitcnt vmcnt(7)
  buffer_load_dwordx4 a[128:131], v7, s[40:43], s62 offen offset:256
  v_mov_b32_dpp v19, v36 quad_perm:[0,0,0,0] row_mask:0xf bank_mask:0xf
  v_mov_b32_dpp v20, v38 quad_perm:[2,2,2,2] row_mask:0xf bank_mask:0xf
  s_nop 0
  v_add_f32_dpp v19, v37, v19 quad_perm:[1,1,1,1] row_mask:0xf bank_mask:0xf
  v_add_f32_dpp v20, v39, v20 quad_perm:[3,3,3,3] row_mask:0xf bank_mask:0xf
  v_add_f32 v19, v19, v20
  v_cvt_pk_bf16_f32 v19, 0, v19
  v_mul_f32 v19, 0x3d93cd3a, v19
  v_cvt_pk_bf16_f32 v19, 0, v19
  v_max_f32 v17, v17, v19
  ds_write_b32 v15, v19 offset:640
  s_call_b64 s[74:75], L_tab
  v_mfma_f32_16x16x32_bf16 v[36:39], v[160:163], v[24:27], 0
  v_mfma_f32_16x16x32_bf16 v[36:39], v[164:167], v[28:31], v[36:39]
  v_mfma_f32_16x16x32_bf16 v[36:39], v[168:171], v[32:35], v[36:39]
  s_mul_i32 s62, s59, 12288
  s_add_u32 s62, s62, s61
  s_waitcnt vmcnt(7)
  buffer_load_dwordx4 v[160:163], v2, s[28:31], s62 offen offset:0 nt
  s_waitcnt vmcnt(7)
  buffer_load_dwordx4 v[164:167], v2, s[28:31], s62 offen offset:256 nt
  s_waitcnt vmcnt(7)
  buffer_load_dwordx4 v[168:171], v2, s[28:31], s62 offen offset:512 nt
  s_add_u32 s59, s59, 1
  s_and_b32 s59, s59, 63
  s_add_u32 s62, s64, 71680
  s_waitcnt vmcnt(7)
  buffer_load_dwordx4 a[132:135], v7, s[40:43], s62 offen offset:256
  v_mov_b32_dpp v19, v36 quad_perm:[0,0,0,0] row_mask:0xf bank_mask:0xf
  v_mov_b32_dpp v20, v38 quad_perm:[2,2,2,2] row_mask:0xf bank_mask:0xf
  s_nop 0
  v_add_f32_dpp v19, v37, v19 quad_perm:[1,1,1,1] row_mask:0xf bank_mask:0xf
  v_add_f32_dpp v20, v39, v20 quad_perm:[3,3,3,3] row_mask:0xf bank_mask:0xf
  v_add_f32 v19, v19, v20
  v_cvt_pk_bf16_f32 v19, 0, v19
  v_mul_f32 v19, 0x3d93cd3a, v19
  v_cvt_pk_bf16_f32 v19, 0, v19
  v_max_f32 v17, v17, v19
  ds_write_b32 v15, v19 offset:672
  s_call_b64 s[74:75], L_tab
  v_mfma_f32_16x16x32_bf16 v[36:39], v[172:175], v[24:27], 0
  v_mfma_f32_16x16x32_bf16 v[36:39], v[176:179], v[28:31], v[36:39]
  v_mfma_f32_16x16x32_bf16 v[36:39], v[180:183], v[32:35], v[36:39]
  s_mul_i32 s62, s59, 12288
  s_add_u32 s62, s62, s61
  s_waitcnt vmcnt(7)
  buffer_load_dwordx4 v[172:175], v2, s[28:31], s62 offen offset:0 nt
  s_waitcnt vmcnt(7)
  buffer_load_dwordx4 v[176:179], v2, s[28:31], s62 offen offset:256 nt
  s_waitcnt vmcnt(7)
  buffer_load_dwordx4 v[180:183], v2, s[28:31], s62 offen offset:512 nt
  s_add_u32 s59, s59, 1
  s_and_b32 s59, s59, 63
  s_add_u32 s62, s64, 61440
  s_waitcnt vmcnt(7)
  buffer_load_dwordx4 a[136:139], v7, s[40:43], s62 offen offset:512
  v_mov_b32_dpp v19, v36 quad_perm:[0,0,0,0] row_mask:0xf bank_mask:0xf
  v_mov_b32_dpp v20, v38 quad_perm:[2,2,2,2] row_mask:0xf bank_mask:0xf
  s_nop 0
  v_add_f32_dpp v19, v37, v19 quad_perm:[1,1,1,1] row_mask:0xf bank_mask:0xf
  v_add_f32_dpp v20, v39, v20 quad_perm:[3,3,3,3] row_mask:0xf bank_mask:0xf
  v_add_f32 v19, v19, v20
  v_cvt_pk_bf16_f32 v19, 0, v19
  v_mul_f32 v19, 0x3d93cd3a, v19
  v_cvt_pk_bf16_f32 v19, 0, v19
  v_max_f32 v17, v17, v19
  ds_write_b32 v15, v19 offset:704
  s_call_b64 s[74:75], L_tab
  v_mfma_f32_16x16x32_bf16 v[36:39], v[184:187], v[24:27], 0
  v_mfma_f32_16x16x32_bf16 v[36:39], v[188:191], v[28:31], v[36:39]
  v_mfma_f32_16x16x32_bf16 v[36:39], v[192:195], v[32:35], v[36:39]
  s_mul_i32 s62, s59, 12288
  s_add_u32 s62, s62, s61
  s_waitcnt vmcnt(7)
  buffer_load_dwordx4 v[184:187], v2, s[28:31], s62 offen offset:0 nt
  s_waitcnt vmcnt(7)
  buffer_load_dwordx4 v[188:191], v2, s[28:31], s62 offen offset:256 nt
  s_waitcnt vmcnt(7)
  buffer_load_dwordx4 v[192:195], v2, s[28:31], s62 offen offset:512 nt
  s_add_u32 s59, s59, 1
  s_and_b32 s59, s59, 63
  s_add_u32 s62, s64, 71680
  s_waitcnt vmcnt(7)
  buffer_load_dwordx4 a[140:143], v7, s[40:43], s62 offen offset:512
  v_mov_b32_dpp v19, v36 quad_perm:[0,0,0,0] row_mask:0xf bank_mask:0xf
  v_mov_b32_dpp v20, v38 quad_perm:[2,2,2,2] row_mask:0xf bank_mask:0xf
  s_nop 0
  v_add_f32_dpp v19, v37, v19 quad_perm:[1,1,1,1] row_mask:0xf bank_mask:0xf
  v_add_f32_dpp v20, v39, v20 quad_perm:[3,3,3,3] row_mask:0xf bank_mask:0xf
  v_add_f32 v19, v19, v20
  v_cvt_pk_bf16_f32 v19, 0, v19
  v_mul_f32 v19, 0x3d93cd3a, v19
  v_cvt_pk_bf16_f32 v19, 0, v19
  v_max_f32 v17, v17, v19
  ds_write_b32 v15, v19 offset:736
  s_call_b64 s[74:75], L_tab
  v_mfma_f32_16x16x32_bf16 v[36:39], v[196:199], v[24:27], 0
  v_mfma_f32_16x16x32_bf16 v[36:39], v[200:203], v[28:31], v[36:39]
  v_mfma_f32_16x16x32_bf16 v[36:39], v[204:207], v[32:35], v[36:39]
  s_mul_i32 s62, s59, 12288
  s_add_u32 s62, s62, s61
  s_waitcnt vmcnt(7)
  buffer_load_dwordx4 v[196:199], v2, s[28:31], s62 offen offset:0 nt
  s_waitcnt vmcnt(7)
  buffer_load_dwordx4 v[200:203], v2, s[28:31], s62 offen offset:256 nt
  s_waitcnt vmcnt(7)
  buffer_load_dwordx4 v[204:207], v2, s[28:31], s62 offen offset:512 nt
  s_add_u32 s59, s59, 1
  s_and_b32 s59, s59, 63
  s_add_u32 s62, s64, 61440
  s_waitcnt vmcnt(7)
  buffer_load_dwordx4 a[144:147], v7, s[40:43], s62 offen offset:768
  v_mov_b32_dpp v19, v36 quad_perm:[0,0,0,0] row_mask:0xf bank_mask:0xf
  v_mov_b32_dpp v20, v38 quad_perm:[2,2,2,2] row_mask:0xf bank_mask:0xf
  s_nop 0
  v_add_f32_dpp v19, v37, v19 quad_perm:[1,1,1,1] row_mask:0xf bank_mask:0xf
  v_add_f32_dpp v20, v39, v20 quad_perm:[3,3,3,3] row_mask:0xf bank_mask:0xf
  v_add_f32 v19, v19, v20
  v_cvt_pk_bf16_f32 v19, 0, v19
  v_mul_f32 v19, 0x3d93cd3a, v19
  v_cvt_pk_bf16_f32 v19, 0, v19
  v_max_f32 v17, v17, v19
  ds_write_b32 v15, v19 offset:768
  s_call_b64 s[74:75], L_tab
  v_mfma_f32_16x16x32_bf16 v[36:39], v[208:211], v[24:27], 0
  v_mfma_f32_16x16x32_bf16 v[36:39], v[212:215], v[28:31], v[36:39]
  v_mfma_f32_16x16x32_bf16 v[36:39], v[216:219], v[32:35], v[36:39]
  s_mul_i32 s62, s59, 12288
  s_add_u32 s62, s62, s61
  s_waitcnt vmcnt(7)
  buffer_load_dwordx4 v[208:211], v2, s[28:31], s62 offen offset:0 nt
  s_waitcnt vmcnt(7)
  buffer_load_dwordx4 v[212:215], v2, s[28:31], s62 offen offset:256 nt
  s_waitcnt vmcnt(7)
  buffer_load_dwordx4 v[216:219], v2, s[28:31], s62 offen offset:512 nt
  s_add_u32 s59, s59, 1
  s_and_b32 s59, s59, 63
  s_add_u32 s62, s64, 71680
  s_waitcnt vmcnt(7)
  buffer_load_dwordx4 a[148:151], v7, s[40:43], s62 offen offset:768
  v_mov_b32_dpp v19, v36 quad_perm:[0,0,0,0] row_mask:0xf bank_mask:0xf
  v_mov_b32_dpp v20, v38 quad_perm:[2,2,2,2] row_mask:0xf bank_mask:0xf
  s_nop 0
  v_add_f32_dpp v19, v37, v19 quad_perm:[1,1,1,1] row_mask:0xf bank_mask:0xf
  v_add_f32_dpp v20, v39, v20 quad_perm:[3,3,3,3] row_mask:0xf bank_mask:0xf
  v_add_f32 v19, v19, v20
  v_cvt_pk_bf16_f32 v19, 0, v19
  v_mul_f32 v19, 0x3d93cd3a, v19
  v_cvt_pk_bf16_f32 v19, 0, v19
  v_max_f32 v17, v17, v19
  ds_write_b32 v15, v19 offset:800
  s_call_b64 s[74:75], L_tab
  v_mfma_f32_16x16x32_bf16 v[36:39], v[220:223], v[24:27], 0
  v_mfma_f32_16x16x32_bf16 v[36:39], v[224:227], v[28:31], v[36:39]
  v_mfma_f32_16x16x32_bf16 v[36:39], v[228:231], v[32:35], v[36:39]
  s_mul_i32 s62, s59, 12288
  s_add_u32 s62, s62, s61
  s_waitcnt vmcnt(7)
  buffer_load_dwordx4 v[220:223], v2, s[28:31], s62 offen offset:0 nt
  s_waitcnt vmcnt(7)
  buffer_load_dwordx4 v[224:227], v2, s[28:31], s62 offen offset:256 nt
  s_waitcnt vmcnt(7)
  buffer_load_dwordx4 v[228:231], v2, s[28:31], s62 offen offset:512 nt
  s_add_u32 s59, s59, 1
  s_and_b32 s59, s59, 63
  s_add_u32 s62, s64, 61440
  s_waitcnt vmcnt(7)
  buffer_load_dwordx4 a[152:155], v7, s[40:43], s62 offen offset:1024
  v_mov_b32_dpp v19, v36 quad_perm:[0,0,0,0] row_mask:0xf bank_mask:0xf
  v_mov_b32_dpp v20, v38 quad_perm:[2,2,2,2] row_mask:0xf bank_mask:0xf
  s_nop 0
  v_add_f32_dpp v19, v37, v19 quad_perm:[1,1,1,1] row_mask:0xf bank_mask:0xf
  v_add_f32_dpp v20, v39, v20 quad_perm:[3,3,3,3] row_mask:0xf bank_mask:0xf
  v_add_f32 v19, v19, v20
  v_cvt_pk_bf16_f32 v19, 0, v19
  v_mul_f32 v19, 0x3d93cd3a, v19
  v_cvt_pk_bf16_f32 v19, 0, v19
  v_max_f32 v17, v17, v19
  ds_write_b32 v15, v19 offset:832
  s_call_b64 s[74:75], L_tab
  v_mfma_f32_16x16x32_bf16 v[36:39], v[232:235], v[24:27], 0
  v_mfma_f32_16x16x32_bf16 v[36:39], v[236:239], v[28:31], v[36:39]
  v_mfma_f32_16x16x32_bf16 v[36:39], v[240:243], v[32:35], v[36:39]
  s_mul_i32 s62, s59, 12288
  s_add_u32 s62, s62, s61
  s_waitcnt vmcnt(7)
  buffer_load_dwordx4 v[232:235], v2, s[28:31], s62 offen offset:0 nt
  s_waitcnt vmcnt(7)
  buffer_load_dwordx4 v[236:239], v2, s[28:31], s62 offen offset:256 nt
  s_waitcnt vmcnt(7)
  buffer_load_dwordx4 v[240:243], v2, s[28:31], s62 offen offset:512 nt
  s_add_u32 s59, s59, 1
  s_and_b32 s59, s59, 63
  s_add_u32 s62, s64, 71680
  s_waitcnt vmcnt(7)
  buffer_load_dwordx4 a[156:159], v7, s[40:43], s62 offen offset:1024
  v_mov_b32_dpp v19, v36 quad_perm:[0,0,0,0] row_mask:0xf bank_mask:0xf
  v_mov_b32_dpp v20, v38 quad_perm:[2,2,2,2] row_mask:0xf bank_mask:0xf
  s_nop 0
  v_add_f32_dpp v19, v37, v19 quad_perm:[1,1,1,1] row_mask:0xf bank_mask:0xf
  v_add_f32_dpp v20, v39, v20 quad_perm:[3,3,3,3] row_mask:0xf bank_mask:0xf
  v_add_f32 v19, v19, v20
  v_cvt_pk_bf16_f32 v19, 0, v19
  v_mul_f32 v19, 0x3d93cd3a, v19
  v_cvt_pk_bf16_f32 v19, 0, v19
  v_max_f32 v17, v17, v19
  ds_write_b32 v15, v19 offset:864
  s_call_b64 s[74:75], L_tab
  v_mfma_f32_16x16x32_bf16 v[36:39], v[100:103], v[24:27], 0
  v_mfma_f32_16x16x32_bf16 v[36:39], v[104:107], v[28:31], v[36:39]
  v_mfma_f32_16x16x32_bf16 v[36:39], v[108:111], v[32:35], v[36:39]
  s_mul_i32 s62, s59, 12288
  s_add_u32 s62, s62, s61
  s_waitcnt vmcnt(7)
  buffer_load_dwordx4 v[100:103], v2, s[28:31], s62 offen offset:0 nt
  s_waitcnt vmcnt(7)
  buffer_load_dwordx4 v[104:107], v2, s[28:31], s62 offen offset:256 nt
  s_waitcnt vmcnt(7)
  buffer_load_dwordx4 v[108:111], v2, s[28:31], s62 offen offset:512 nt
  s_add_u32 s59, s59, 1
  s_and_b32 s59, s59, 63
  s_add_u32 s62, s64, 81920
  s_waitcnt vmcnt(7)
  buffer_load_dwordx4 a[160:163], v7, s[40:43], s62 offen offset:0
  v_mov_b32_dpp v19, v36 quad_perm:[0,0,0,0] row_mask:0xf bank_mask:0xf
  v_mov_b32_dpp v20, v38 quad_perm:[2,2,2,2] row_mask:0xf bank_mask:0xf
  s_nop 0
  v_add_f32_dpp v19, v37, v19 quad_perm:[1,1,1,1] row_mask:0xf bank_mask:0xf
  v_add_f32_dpp v20, v39, v20 quad_perm:[3,3,3,3] row_mask:0xf bank_mask:0xf
  v_add_f32 v19, v19, v20
  v_cvt_pk_bf16_f32 v19, 0, v19
  v_mul_f32 v19, 0x3d93cd3a, v19
  v_cvt_pk_bf16_f32 v19, 0, v19
  v_max_f32 v17, v17, v19
  ds_write_b32 v15, v19 offset:896
  s_call_b64 s[74:75], L_tab
  v_mfma_f32_16x16x32_bf16 v[36:39], v[112:115], v[24:27], 0
  v_mfma_f32_16x16x32_bf16 v[36:39], v[116:119], v[28:31], v[36:39]
  v_mfma_f32_16x16x32_bf16 v[36:39], v[120:123], v[32:35], v[36:39]
  s_mul_i32 s62, s59, 12288
  s_add_u32 s62, s62, s61
  s_waitcnt vmcnt(7)
  buffer_load_dwordx4 v[112:115], v2, s[28:31], s62 offen offset:0 nt
  s_waitcnt vmcnt(7)
  buffer_load_dwordx4 v[116:119], v2, s[28:31], s62 offen offset:256 nt
  s_waitcnt vmcnt(7)
  buffer_load_dwordx4 v[120:123], v2, s[28:31], s62 offen offset:512 nt
  s_add_u32 s59, s59, 1
  s_and_b32 s59, s59, 63
  s_add_u32 s62, s64, 92160
  s_waitcnt vmcnt(7)
  buffer_load_dwordx4 a[164:167], v7, s[40:43], s62 offen offset:0
  v_mov_b32_dpp v19, v36 quad_perm:[0,0,0,0] row_mask:0xf bank_mask:0xf
  v_mov_b32_dpp v20, v38 quad_perm:[2,2,2,2] row_mask:0xf bank_mask:0xf
  s_nop 0
  v_add_f32_dpp v19, v37, v19 quad_perm:[1,1,1,1] row_mask:0xf bank_mask:0xf
  v_add_f32_dpp v20, v39, v20 quad_perm:[3,3,3,3] row_mask:0xf bank_mask:0xf
  v_add_f32 v19, v19, v20
  v_cvt_pk_bf16_f32 v19, 0, v19
  v_mul_f32 v19, 0x3d93cd3a, v19
  v_cvt_pk_bf16_f32 v19, 0, v19
  v_max_f32 v17, v17, v19
  ds_write_b32 v15, v19 offset:928
  s_call_b64 s[74:75], L_tab
  v_mfma_f32_16x16x32_bf16 v[36:39], v[124:127], v[24:27], 0
  v_mfma_f32_16x16x32_bf16 v[36:39], v[128:131], v[28:31], v[36:39]
  v_mfma_f32_16x16x32_bf16 v[36:39], v[132:135], v[32:35], v[36:39]
  s_mul_i32 s62, s59, 12288
  s_add_u32 s62, s62, s61
  s_waitcnt vmcnt(7)
  buffer_load_dwordx4 v[124:127], v2, s[28:31], s62 offen offset:0 nt
  s_waitcnt vmcnt(7)
  buffer_load_dwordx4 v[128:131], v2, s[28:31], s62 offen offset:256 nt
  s_waitcnt vmcnt(7)
  buffer_load_dwordx4 v[132:135], v2, s[28:31], s62 offen offset:512 nt
  s_add_u32 s59, s59, 1
  s_and_b32 s59, s59, 63
  s_add_u32 s62, s64, 81920
  s_waitcnt vmcnt(7)
  buffer_load_dwordx4 a[168:171], v7, s[40:43], s62 offen offset:256
  v_mov_b32_dpp v19, v36 quad_perm:[0,0,0,0] row_mask:0xf bank_mask:0xf
  v_mov_b32_dpp v20, v38 quad_perm:[2,2,2,2] row_mask:0xf bank_mask:0xf
  s_nop 0
  v_add_f32_dpp v19, v37, v19 quad_perm:[1,1,1,1] row_mask:0xf bank_mask:0xf
  v_add_f32_dpp v20, v39, v20 quad_perm:[3,3,3,3] row_mask:0xf bank_mask:0xf
  v_add_f32 v19, v19, v20
  v_cvt_pk_bf16_f32 v19, 0, v19
  v_mul_f32 v19, 0x3d93cd3a, v19
  v_cvt_pk_bf16_f32 v19, 0, v19
  v_max_f32 v17, v17, v19
  ds_write_b32 v15, v19 offset:960
  s_call_b64 s[74:75], L_tab
  v_mfma_f32_16x16x32_bf16 v[36:39], v[136:139], v[24:27], 0
  v_mfma_f32_16x16x32_bf16 v[36:39], v[140:143], v[28:31], v[36:39]
  v_mfma_f32_16x16x32_bf16 v[36:39], v[144:147], v[32:35], v[36:39]
  s_mul_i32 s62, s59, 12288
  s_add_u32 s62, s62, s61
  s_waitcnt vmcnt(7)
  buffer_load_dwordx4 v[136:139], v2, s[28:31], s62 offen offset:0 nt
  s_waitcnt vmcnt(7)
  buffer_load_dwordx4 v[140:143], v2, s[28:31], s62 offen offset:256 nt
  s_waitcnt vmcnt(7)
  buffer_load_dwordx4 v[144:147], v2, s[28:31], s62 offen offset:512 nt
  s_add_u32 s59, s59, 1
  s_and_b32 s59, s59, 63
  s_add_u32 s62, s64, 92160
  s_waitcnt vmcnt(7)
  buffer_load_dwordx4 a[172:175], v7, s[40:43], s62 offen offset:256
  v_mov_b32_dpp v19, v36 quad_perm:[0,0,0,0] row_mask:0xf bank_mask:0xf
  v_mov_b32_dpp v20, v38 quad_perm:[2,2,2,2] row_mask:0xf bank_mask:0xf
  s_nop 0
  v_add_f32_dpp v19, v37, v19 quad_perm:[1,1,1,1] row_mask:0xf bank_mask:0xf
  v_add_f32_dpp v20, v39, v20 quad_perm:[3,3,3,3] row_mask:0xf bank_mask:0xf
  v_add_f32 v19, v19, v20
  v_cvt_pk_bf16_f32 v19, 0, v19
  v_mul_f32 v19, 0x3d93cd3a, v19
  v_cvt_pk_bf16_f32 v19, 0, v19
  v_max_f32 v17, v17, v19
  ds_write_b32 v15, v19 offset:992
  s_call_b64 s[74:75], L_tab
  v_mfma_f32_16x16x32_bf16 v[36:39], v[148:151], v[24:27], 0
  v_mfma_f32_16x16x32_bf16 v[36:39], v[152:155], v[28:31], v[36:39]
  v_mfma_f32_16x16x32_bf16 v[36:39], v[156:159], v[32:35], v[36:39]
  s_mul_i32 s62, s59, 12288
  s_add_u32 s62, s62, s61
  s_waitcnt vmcnt(7)
  buffer_load_dwordx4 v[148:151], v2, s[28:31], s62 offen offset:0 nt
  s_waitcnt vmcnt(7)
  buffer_load_dwordx4 v[152:155], v2, s[28:31], s62 offen offset:256 nt
  s_waitcnt vmcnt(7)
  buffer_load_dwordx4 v[156:159], v2, s[28:31], s62 offen offset:512 nt
  s_add_u32 s59, s59, 1
  s_and_b32 s59, s59, 63
  s_add_u32 s62, s64, 81920
  s_waitcnt vmcnt(7)
  buffer_load_dwordx4 a[176:179], v7, s[40:43], s62 offen offset:512
  v_mov_b32_dpp v19, v36 quad_perm:[0,0,0,0] row_mask:0xf bank_mask:0xf
  v_mov_b32_dpp v20, v38 quad_perm:[2,2,2,2] row_mask:0xf bank_mask:0xf
  s_nop 0
  v_add_f32_dpp v19, v37, v19 quad_perm:[1,1,1,1] row_mask:0xf bank_mask:0xf
  v_add_f32_dpp v20, v39, v20 quad_perm:[3,3,3,3] row_mask:0xf bank_mask:0xf
  v_add_f32 v19, v19, v20
  v_cvt_pk_bf16_f32 v19, 0, v19
  v_mul_f32 v19, 0x3d93cd3a, v19
  v_cvt_pk_bf16_f32 v19, 0, v19
  v_max_f32 v17, v17, v19
  ds_write_b32 v15, v19 offset:1024
  s_call_b64 s[74:75], L_tab
  v_mfma_f32_16x16x32_bf16 v[36:39], v[160:163], v[24:27], 0
  v_mfma_f32_16x16x32_bf16 v[36:39], v[164:167], v[28:31], v[36:39]
  v_mfma_f32_16x16x32_bf16 v[36:39], v[168:171], v[32:35], v[36:39]
  s_mul_i32 s62, s59, 12288
  s_add_u32 s62, s62, s61
  s_waitcnt vmcnt(7)
  buffer_load_dwordx4 v[160:163], v2, s[28:31], s62 offen offset:0 nt
  s_waitcnt vmcnt(7)
  buffer_load_dwordx4 v[164:167], v2, s[28:31], s62 offen offset:256 nt
  s_waitcnt vmcnt(7)
  buffer_load_dwordx4 v[168:171], v2, s[28:31], s62 offen offset:512 nt
  s_add_u32 s59, s59, 1
  s_and_b32 s59, s59, 63
  s_add_u32 s62, s64, 92160
  s_waitcnt vmcnt(7)
  buffer_load_dwordx4 a[180:183], v7, s[40:43], s62 offen offset:512
  v_mov_b32_dpp v19, v36 quad_perm:[0,0,0,0] row_mask:0xf bank_mask:0xf
  v_mov_b32_dpp v20, v38 quad_perm:[2,2,2,2] row_mask:0xf bank_mask:0xf
  s_nop 0
  v_add_f32_dpp v19, v37, v19 quad_perm:[1,1,1,1] row_mask:0xf bank_mask:0xf
  v_add_f32_dpp v20, v39, v20 quad_perm:[3,3,3,3] row_mask:0xf bank_mask:0xf
  v_add_f32 v19, v19, v20
  v_cvt_pk_bf16_f32 v19, 0, v19
  v_mul_f32 v19, 0x3d93cd3a, v19
  v_cvt_pk_bf16_f32 v19, 0, v19
  v_max_f32 v17, v17, v19
  ds_write_b32 v15, v19 offset:1056
  s_call_b64 s[74:75], L_tab
  v_mfma_f32_16x16x32_bf16 v[36:39], v[172:175], v[24:27], 0
  v_mfma_f32_16x16x32_bf16 v[36:39], v[176:179], v[28:31], v[36:39]
  v_mfma_f32_16x16x32_bf16 v[36:39], v[180:183], v[32:35], v[36:39]
  s_mul_i32 s62, s59, 12288
  s_add_u32 s62, s62, s61
  s_waitcnt vmcnt(7)
  buffer_load_dwordx4 v[172:175], v2, s[28:31], s62 offen offset:0 nt
  s_waitcnt vmcnt(7)
  buffer_load_dwordx4 v[176:179], v2, s[28:31], s62 offen offset:256 nt
  s_waitcnt vmcnt(7)
  buffer_load_dwordx4 v[180:183], v2, s[28:31], s62 offen offset:512 nt
  s_add_u32 s59, s59, 1
  s_and_b32 s59, s59, 63
  s_add_u32 s62, s64, 81920
  s_waitcnt vmcnt(7)
  buffer_load_dwordx4 a[184:187], v7, s[40:43], s62 offen offset:768
  v_mov_b32_dpp v19, v36 quad_perm:[0,0,0,0] row_mask:0xf bank_mask:0xf
  v_mov_b32_dpp v20, v38 quad_perm:[2,2,2,2] row_mask:0xf bank_mask:0xf
  s_nop 0
  v_add_f32_dpp v19, v37, v19 quad_perm:[1,1,1,1] row_mask:0xf bank_mask:0xf
  v_add_f32_dpp v20, v39, v20 quad_perm:[3,3,3,3] row_mask:0xf bank_mask:0xf
  v_add_f32 v19, v19, v20
  v_cvt_pk_bf16_f32 v19, 0, v19
  v_mul_f32 v19, 0x3d93cd3a, v19
  v_cvt_pk_bf16_f32 v19, 0, v19
  v_max_f32 v17, v17, v19
  ds_write_b32 v15, v19 offset:1088
  s_call_b64 s[74:75], L_tab
  v_mfma_f32_16x16x32_bf16 v[36:39], v[184:187], v[24:27], 0
  v_mfma_f32_16x16x32_bf16 v[36:39], v[188:191], v[28:31], v[36:39]
  v_mfma_f32_16x16x32_bf16 v[36:39], v[192:195], v[32:35], v[36:39]
  s_mul_i32 s62, s59, 12288
  s_add_u32 s62, s62, s61
  s_waitcnt vmcnt(7)
  buffer_load_dwordx4 v[184:187], v2, s[28:31], s62 offen offset:0 nt
  s_waitcnt vmcnt(7)
  buffer_load_dwordx4 v[188:191], v2, s[28:31], s62 offen offset:256 nt
  s_waitcnt vmcnt(7)
  buffer_load_dwordx4 v[192:195], v2, s[28:31], s62 offen offset:512 nt
  s_add_u32 s59, s59, 1
  s_and_b32 s59, s59, 63
  s_add_u32 s62, s64, 92160
  s_waitcnt vmcnt(7)
  buffer_load_dwordx4 a[188:191], v7, s[40:43], s62 offen offset:768
  v_mov_b32_dpp v19, v36 quad_perm:[0,0,0,0] row_mask:0xf bank_mask:0xf
  v_mov_b32_dpp v20, v38 quad_perm:[2,2,2,2] row_mask:0xf bank_mask:0xf
  s_nop 0
  v_add_f32_dpp v19, v37, v19 quad_perm:[1,1,1,1] row_mask:0xf bank_mask:0xf
  v_add_f32_dpp v20, v39, v20 quad_perm:[3,3,3,3] row_mask:0xf bank_mask:0xf
  v_add_f32 v19, v19, v20
  v_cvt_pk_bf16_f32 v19, 0, v19
  v_mul_f32 v19, 0x3d93cd3a, v19
  v_cvt_pk_bf16_f32 v19, 0, v19
  v_max_f32 v17, v17, v19
  ds_write_b32 v15, v19 offset:1120
  s_call_b64 s[74:75], L_tab
  v_mfma_f32_16x16x32_bf16 v[36:39], v[196:199], v[24:27], 0
  v_mfma_f32_16x16x32_bf16 v[36:39], v[200:203], v[28:31], v[36:39]
  v_mfma_f32_16x16x32_bf16 v[36:39], v[204:207], v[32:35], v[36:39]
  s_mul_i32 s62, s59, 12288
  s_add_u32 s62, s62, s61
  s_waitcnt vmcnt(7)
  buffer_load_dwordx4 v[196:199], v2, s[28:31], s62 offen offset:0 nt
  s_waitcnt vmcnt(7)
  buffer_load_dwordx4 v[200:203], v2, s[28:31], s62 offen offset:256 nt
  s_waitcnt vmcnt(7)
  buffer_load_dwordx4 v[204:207], v2, s[28:31], s62 offen offset:512 nt
  s_add_u32 s59, s59, 1
  s_and_b32 s59, s59, 63
  s_add_u32 s62, s64, 81920
  s_waitcnt vmcnt(7)
  buffer_load_dwordx4 a[192:195], v7, s[40:43], s62 offen offset:1024
  v_mov_b32_dpp v19, v36 quad_perm:[0,0,0,0] row_mask:0xf bank_mask:0xf
  v_mov_b32_dpp v20, v38 quad_perm:[2,2,2,2] row_mask:0xf bank_mask:0xf
  s_nop 0
  v_add_f32_dpp v19, v37, v19 quad_perm:[1,1,1,1] row_mask:0xf bank_mask:0xf
  v_add_f32_dpp v20, v39, v20 quad_perm:[3,3,3,3] row_mask:0xf bank_mask:0xf
  v_add_f32 v19, v19, v20
  v_cvt_pk_bf16_f32 v19, 0, v19
  v_mul_f32 v19, 0x3d93cd3a, v19
  v_cvt_pk_bf16_f32 v19, 0, v19
  v_max_f32 v17, v17, v19
  ds_write_b32 v15, v19 offset:1152
  s_call_b64 s[74:75], L_tab
  v_mfma_f32_16x16x32_bf16 v[36:39], v[208:211], v[24:27], 0
  v_mfma_f32_16x16x32_bf16 v[36:39], v[212:215], v[28:31], v[36:39]
  v_mfma_f32_16x16x32_bf16 v[36:39], v[216:219], v[32:35], v[36:39]
  s_mul_i32 s62, s59, 12288
  s_add_u32 s62, s62, s61
  s_waitcnt vmcnt(7)
  buffer_load_dwordx4 v[208:211], v2, s[28:31], s62 offen offset:0 nt
  s_waitcnt vmcnt(7)
  buffer_load_dwordx4 v[212:215], v2, s[28:31], s62 offen offset:256 nt
  s_waitcnt vmcnt(7)
  buffer_load_dwordx4 v[216:219], v2, s[28:31], s62 offen offset:512 nt
  s_add_u32 s59, s59, 1
  s_and_b32 s59, s59, 63
  s_add_u32 s62, s64, 92160
  s_waitcnt vmcnt(7)
  buffer_load_dwordx4 a[196:199], v7, s[40:43], s62 offen offset:1024
  v_mov_b32_dpp v19, v36 quad_perm:[0,0,0,0] row_mask:0xf bank_mask:0xf
  v_mov_b32_dpp v20, v38 quad_perm:[2,2,2,2] row_mask:0xf bank_mask:0xf
  s_nop 0
  v_add_f32_dpp v19, v37, v19 quad_perm:[1,1,1,1] row_mask:0xf bank_mask:0xf
  v_add_f32_dpp v20, v39, v20 quad_perm:[3,3,3,3] row_mask:0xf bank_mask:0xf
  v_add_f32 v19, v19, v20
  v_cvt_pk_bf16_f32 v19, 0, v19
  v_mul_f32 v19, 0x3d93cd3a, v19
  v_cvt_pk_bf16_f32 v19, 0, v19
  v_max_f32 v17, v17, v19
  ds_write_b32 v15, v19 offset:1184
  s_call_b64 s[74:75], L_tab
  v_mfma_f32_16x16x32_bf16 v[36:39], v[220:223], v[24:27], 0
  v_mfma_f32_16x16x32_bf16 v[36:39], v[224:227], v[28:31], v[36:39]
  v_mfma_f32_16x16x32_bf16 v[36:39], v[228:231], v[32:35], v[36:39]
  s_mul_i32 s62, s59, 12288
  s_add_u32 s62, s62, s61
  s_waitcnt vmcnt(7)
  buffer_load_dwordx4 v[220:223], v2, s[28:31], s62 offen offset:0 nt
  s_waitcnt vmcnt(7)
  buffer_load_dwordx4 v[224:227], v2, s[28:31], s62 offen offset:256 nt
  s_waitcnt vmcnt(7)
  buffer_load_dwordx4 v[228:231], v2, s[28:31], s62 offen offset:512 nt
  s_add_u32 s59, s59, 1
  s_and_b32 s59, s59, 63
  s_add_u32 s62, s64, 102400
  s_waitcnt vmcnt(7)
  buffer_load_dwordx4 a[200:203], v7, s[40:43], s62 offen offset:0
  v_mov_b32_dpp v19, v36 quad_perm:[0,0,0,0] row_mask:0xf bank_mask:0xf
  v_mov_b32_dpp v20, v38 quad_perm:[2,2,2,2] row_mask:0xf bank_mask:0xf
  s_nop 0
  v_add_f32_dpp v19, v37, v19 quad_perm:[1,1,1,1] row_mask:0xf bank_mask:0xf
  v_add_f32_dpp v20, v39, v20 quad_perm:[3,3,3,3] row_mask:0xf bank_mask:0xf
  v_add_f32 v19, v19, v20
  v_cvt_pk_bf16_f32 v19, 0, v19
  v_mul_f32 v19, 0x3d93cd3a, v19
  v_cvt_pk_bf16_f32 v19, 0, v19
  v_max_f32 v17, v17, v19
  ds_write_b32 v15, v19 offset:1216
  s_call_b64 s[74:75], L_tab
  v_mfma_f32_16x16x32_bf16 v[36:39], v[232:235], v[24:27], 0
  v_mfma_f32_16x16x32_bf16 v[36:39], v[236:239], v[28:31], v[36:39]
  v_mfma_f32_16x16x32_bf16 v[36:39], v[240:243], v[32:35], v[36:39]
  s_mul_i32 s62, s59, 12288
  s_add_u32 s62, s62, s61
  s_waitcnt vmcnt(7)
  buffer_load_dwordx4 v[232:235], v2, s[28:31], s62 offen offset:0 nt
  s_waitcnt vmcnt(7)
  buffer_load_dwordx4 v[236:239], v2, s[28:31], s62 offen offset:256 nt
  s_waitcnt vmcnt(7)
  buffer_load_dwordx4 v[240:243], v2, s[28:31], s62 offen offset:512 nt
  s_add_u32 s59, s59, 1
  s_and_b32 s59, s59, 63
  s_add_u32 s62, s64, 112640
  s_waitcnt vmcnt(7)
  buffer_load_dwordx4 a[204:207], v7, s[40:43], s62 offen offset:0
  v_mov_b32_dpp v19, v36 quad_perm:[0,0,0,0] row_mask:0xf bank_mask:0xf
  v_mov_b32_dpp v20, v38 quad_perm:[2,2,2,2] row_mask:0xf bank_mask:0xf
  s_nop 0
  v_add_f32_dpp v19, v37, v19 quad_perm:[1,1,1,1] row_mask:0xf bank_mask:0xf
  v_add_f32_dpp v20, v39, v20 quad_perm:[3,3,3,3] row_mask:0xf bank_mask:0xf
  v_add_f32 v19, v19, v20
  v_cvt_pk_bf16_f32 v19, 0, v19
  v_mul_f32 v19, 0x3d93cd3a, v19
  v_cvt_pk_bf16_f32 v19, 0, v19
  v_max_f32 v17, v17, v19
  ds_write_b32 v15, v19 offset:1248
  s_call_b64 s[74:75], L_tab
  v_mfma_f32_16x16x32_bf16 v[36:39], v[100:103], v[24:27], 0
  v_mfma_f32_16x16x32_bf16 v[36:39], v[104:107], v[28:31], v[36:39]
  v_mfma_f32_16x16x32_bf16 v[36:39], v[108:111], v[32:35], v[36:39]
  s_mul_i32 s62, s59, 12288
  s_add_u32 s62, s62, s61
  s_waitcnt vmcnt(7)
  buffer_load_dwordx4 v[100:103], v2, s[28:31], s62 offen offset:0 nt
  s_waitcnt vmcnt(7)
  buffer_load_dwordx4 v[104:107], v2, s[28:31], s62 offen offset:256 nt
  s_waitcnt vmcnt(7)
  buffer_load_dwordx4 v[108:111], v2, s[28:31], s62 offen offset:512 nt
  s_add_u32 s59, s59, 1
  s_and_b32 s59, s59, 63
  s_add_u32 s62, s64, 102400
  s_waitcnt vmcnt(7)
  buffer_load_dwordx4 a[208:211], v7, s[40:43], s62 offen offset:256
  v_mov_b32_dpp v19, v36 quad_perm:[0,0,0,0] row_mask:0xf bank_mask:0xf
  v_mov_b32_dpp v20, v38 quad_perm:[2,2,2,2] row_mask:0xf bank_mask:0xf
  s_nop 0
  v_add_f32_dpp v19, v37, v19 quad_perm:[1,1,1,1] row_mask:0xf bank_mask:0xf
  v_add_f32_dpp v20, v39, v20 quad_perm:[3,3,3,3] row_mask:0xf bank_mask:0xf
  v_add_f32 v19, v19, v20
  v_cvt_pk_bf16_f32 v19, 0, v19
  v_mul_f32 v19, 0x3d93cd3a, v19
  v_cvt_pk_bf16_f32 v19, 0, v19
  v_max_f32 v17, v17, v19
  ds_write_b32 v15, v19 offset:1280
  s_call_b64 s[74:75], L_tab
  v_mfma_f32_16x16x32_bf16 v[36:39], v[112:115], v[24:27], 0
  v_mfma_f32_16x16x32_bf16 v[36:39], v[116:119], v[28:31], v[36:39]
  v_mfma_f32_16x16x32_bf16 v[36:39], v[120:123], v[32:35], v[36:39]
  s_mul_i32 s62, s59, 12288
  s_add_u32 s62, s62, s61
  s_waitcnt vmcnt(7)
  buffer_load_dwordx4 v[112:115], v2, s[28:31], s62 offen offset:0 nt
  s_waitcnt vmcnt(7)
  buffer_load_dwordx4 v[116:119], v2, s[28:31], s62 offen offset:256 nt
  s_waitcnt vmcnt(7)
  buffer_load_dwordx4 v[120:123], v2, s[28:31], s62 offen offset:512 nt
  s_add_u32 s59, s59, 1
  s_and_b32 s59, s59, 63
  s_add_u32 s62, s64, 112640
  s_waitcnt vmcnt(7)
  buffer_load_dwordx4 a[212:215], v7, s[40:43], s62 offen offset:256
  v_mov_b32_dpp v19, v36 quad_perm:[0,0,0,0] row_mask:0xf bank_mask:0xf
  v_mov_b32_dpp v20, v38 quad_perm:[2,2,2,2] row_mask:0xf bank_mask:0xf
  s_nop 0
  v_add_f32_dpp v19, v37, v19 quad_perm:[1,1,1,1] row_mask:0xf bank_mask:0xf
  v_add_f32_dpp v20, v39, v20 quad_perm:[3,3,3,3] row_mask:0xf bank_mask:0xf
  v_add_f32 v19, v19, v20
  v_cvt_pk_bf16_f32 v19, 0, v19
  v_mul_f32 v19, 0x3d93cd3a, v19
  v_cvt_pk_bf16_f32 v19, 0, v19
  v_max_f32 v17, v17, v19
  ds_write_b32 v15, v19 offset:1312
  s_call_b64 s[74:75], L_tab
  v_mfma_f32_16x16x32_bf16 v[36:39], v[124:127], v[24:27], 0
  v_mfma_f32_16x16x32_bf16 v[36:39], v[128:131], v[28:31], v[36:39]
  v_mfma_f32_16x16x32_bf16 v[36:39], v[132:135], v[32:35], v[36:39]
  s_mul_i32 s62, s59, 12288
  s_add_u32 s62, s62, s61
  s_waitcnt vmcnt(7)
  buffer_load_dwordx4 v[124:127], v2, s[28:31], s62 offen offset:0 nt
  s_waitcnt vmcnt(7)
  buffer_load_dwordx4 v[128:131], v2, s[28:31], s62 offen offset:256 nt
  s_waitcnt vmcnt(7)
  buffer_load_dwordx4 v[132:135], v2, s[28:31], s62 offen offset:512 nt
  s_add_u32 s59, s59, 1
  s_and_b32 s59, s59, 63
  s_add_u32 s62, s64, 102400
  s_waitcnt vmcnt(7)
  buffer_load_dwordx4 a[216:219], v7, s[40:43], s62 offen offset:512
  v_mov_b32_dpp v19, v36 quad_perm:[0,0,0,0] row_mask:0xf bank_mask:0xf
  v_mov_b32_dpp v20, v38 quad_perm:[2,2,2,2] row_mask:0xf bank_mask:0xf
  s_nop 0
  v_add_f32_dpp v19, v37, v19 quad_perm:[1,1,1,1] row_mask:0xf bank_mask:0xf
  v_add_f32_dpp v20, v39, v20 quad_perm:[3,3,3,3] row_mask:0xf bank_mask:0xf
  v_add_f32 v19, v19, v20
  v_cvt_pk_bf16_f32 v19, 0, v19
  v_mul_f32 v19, 0x3d93cd3a, v19
  v_cvt_pk_bf16_f32 v19, 0, v19
  v_max_f32 v17, v17, v19
  ds_write_b32 v15, v19 offset:1344
  s_call_b64 s[74:75], L_tab
  v_mfma_f32_16x16x32_bf16 v[36:39], v[136:139], v[24:27], 0
  v_mfma_f32_16x16x32_bf16 v[36:39], v[140:143], v[28:31], v[36:39]
  v_mfma_f32_16x16x32_bf16 v[36:39], v[144:147], v[32:35], v[36:39]
  s_mul_i32 s62, s59, 12288
  s_add_u32 s62, s62, s61
  s_waitcnt vmcnt(7)
  buffer_load_dwordx4 v[136:139], v2, s[28:31], s62 offen offset:0 nt
  s_waitcnt vmcnt(7)
  buffer_load_dwordx4 v[140:143], v2, s[28:31], s62 offen offset:256 nt
  s_waitcnt vmcnt(7)
  buffer_load_dwordx4 v[144:147], v2, s[28:31], s62 offen offset:512 nt
  s_add_u32 s59, s59, 1
  s_and_b32 s59, s59, 63
  s_add_u32 s62, s64, 112640
  s_waitcnt vmcnt(7)
  buffer_load_dwordx4 a[220:223], v7, s[40:43], s62 offen offset:512
  v_mov_b32_dpp v19, v36 quad_perm:[0,0,0,0] row_mask:0xf bank_mask:0xf
  v_mov_b32_dpp v20, v38 quad_perm:[2,2,2,2] row_mask:0xf bank_mask:0xf
  s_nop 0
  v_add_f32_dpp v19, v37, v19 quad_perm:[1,1,1,1] row_mask:0xf bank_mask:0xf
  v_add_f32_dpp v20, v39, v20 quad_perm:[3,3,3,3] row_mask:0xf bank_mask:0xf
  v_add_f32 v19, v19, v20
  v_cvt_pk_bf16_f32 v19, 0, v19
  v_mul_f32 v19, 0x3d93cd3a, v19
  v_cvt_pk_bf16_f32 v19, 0, v19
  v_max_f32 v17, v17, v19
  ds_write_b32 v15, v19 offset:1376
  s_call_b64 s[74:75], L_tab
  v_mfma_f32_16x16x32_bf16 v[36:39], v[148:151], v[24:27], 0
  v_mfma_f32_16x16x32_bf16 v[36:39], v[152:155], v[28:31], v[36:39]
  v_mfma_f32_16x16x32_bf16 v[36:39], v[156:159], v[32:35], v[36:39]
  s_mul_i32 s62, s59, 12288
  s_add_u32 s62, s62, s61
  s_waitcnt vmcnt(7)
  buffer_load_dwordx4 v[148:151], v2, s[28:31], s62 offen offset:0 nt
  s_waitcnt vmcnt(7)
  buffer_load_dwordx4 v[152:155], v2, s[28:31], s62 offen offset:256 nt
  s_waitcnt vmcnt(7)
  buffer_load_dwordx4 v[156:159], v2, s[28:31], s62 offen offset:512 nt
  s_add_u32 s59, s59, 1
  s_and_b32 s59, s59, 63
  s_add_u32 s62, s64, 102400
  s_waitcnt vmcnt(7)
  buffer_load_dwordx4 a[224:227], v7, s[40:43], s62 offen offset:768
  v_mov_b32_dpp v19, v36 quad_perm:[0,0,0,0] row_mask:0xf bank_mask:0xf
  v_mov_b32_dpp v20, v38 quad_perm:[2,2,2,2] row_mask:0xf bank_mask:0xf
  s_nop 0
  v_add_f32_dpp v19, v37, v19 quad_perm:[1,1,1,1] row_mask:0xf bank_mask:0xf
  v_add_f32_dpp v20, v39, v20 quad_perm:[3,3,3,3] row_mask:0xf bank_mask:0xf
  v_add_f32 v19, v19, v20
  v_cvt_pk_bf16_f32 v19, 0, v19
  v_mul_f32 v19, 0x3d93cd3a, v19
  v_cvt_pk_bf16_f32 v19, 0, v19
  v_max_f32 v17, v17, v19
  ds_write_b32 v15, v19 offset:1408
  v_add_f32 v90, v90, v91
  s_nop 1
  v_add_f32_dpp v90, v90, v90 row_ror:8 row_mask:0xf bank_mask:0xf
  v_mov_b32 v91, v90
  s_nop 1
  v_permlane16_swap_b32 v90, v91
  v_add_f32 v90, v90, v91
  v_mov_b32 v91, v90
  s_nop 1
  v_permlane32_swap_b32 v90, v91
  v_add_f32 v90, v90, v91
  v_cvt_pk_bf16_f32 v90, 0, v90
  v_add_f32 v90, s69, v90
  v_cvt_pk_bf16_f32 v90, v90, v90
  s_lshl_b32 s57, s52, 4
  v_lshl_add_u32 v91, v1, 1, s57
  s_mov_b32 exec_lo, 0x000000ff
  s_mov_b32 exec_hi, 0x00000000
  ds_write_b16 v91, v90 offset:36992
  s_mov_b64 exec, -1
  v_mfma_f32_16x16x32_bf16 v[36:39], v[160:163], v[24:27], 0
  v_mfma_f32_16x16x32_bf16 v[36:39], v[164:167], v[28:31], v[36:39]
  v_mfma_f32_16x16x32_bf16 v[36:39], v[168:171], v[32:35], v[36:39]
  s_mul_i32 s62, s59, 12288
  s_add_u32 s62, s62, s61
  s_waitcnt vmcnt(7)
  buffer_load_dwordx4 v[160:163], v2, s[28:31], s62 offen offset:0 nt
  s_waitcnt vmcnt(7)
  buffer_load_dwordx4 v[164:167], v2, s[28:31], s62 offen offset:256 nt
  s_waitcnt vmcnt(7)
  buffer_load_dwordx4 v[168:171], v2, s[28:31], s62 offen offset:512 nt
  s_add_u32 s59, s59, 1
  s_and_b32 s59, s59, 63
  s_add_u32 s62, s64, 112640
  s_waitcnt vmcnt(7)
  buffer_load_dwordx4 a[228:231], v7, s[40:43], s62 offen offset:768
  v_mov_b32_dpp v19, v36 quad_perm:[0,0,0,0] row_mask:0xf bank_mask:0xf
  v_mov_b32_dpp v20, v38 quad_perm:[2,2,2,2] row_mask:0xf bank_mask:0xf
  s_nop 0
  v_add_f32_dpp v19, v37, v19 quad_perm:[1,1,1,1] row_mask:0xf bank_mask:0xf
  v_add_f32_dpp v20, v39, v20 quad_perm:[3,3,3,3] row_mask:0xf bank_mask:0xf
  v_add_f32 v19, v19, v20
  v_cvt_pk_bf16_f32 v19, 0, v19
  v_mul_f32 v19, 0x3d93cd3a, v19
  v_cvt_pk_bf16_f32 v19, 0, v19
  v_max_f32 v17, v17, v19
  ds_write_b32 v15, v19 offset:1440
  v_mfma_f32_16x16x32_bf16 v[36:39], v[172:175], v[24:27], 0
  v_mfma_f32_16x16x32_bf16 v[36:39], v[176:179], v[28:31], v[36:39]
  v_mfma_f32_16x16x32_bf16 v[36:39], v[180:183], v[32:35], v[36:39]
  s_mul_i32 s62, s59, 12288
  s_add_u32 s62, s62, s61
  s_waitcnt vmcnt(7)
  buffer_load_dwordx4 v[172:175], v2, s[28:31], s62 offen offset:0 nt
  s_waitcnt vmcnt(7)
  buffer_load_dwordx4 v[176:179], v2, s[28:31], s62 offen offset:256 nt
  s_waitcnt vmcnt(7)
  buffer_load_dwordx4 v[180:183], v2, s[28:31], s62 offen offset:512 nt
  s_add_u32 s59, s59, 1
  s_and_b32 s59, s59, 63
  s_add_u32 s62, s64, 102400
  s_waitcnt vmcnt(7)
  buffer_load_dwordx4 a[232:235], v7, s[40:43], s62 offen offset:1024
  v_mov_b32_dpp v19, v36 quad_perm:[0,0,0,0] row_mask:0xf bank_mask:0xf
  v_mov_b32_dpp v20, v38 quad_perm:[2,2,2,2] row_mask:0xf bank_mask:0xf
  s_nop 0
  v_add_f32_dpp v19, v37, v19 quad_perm:[1,1,1,1] row_mask:0xf bank_mask:0xf
  v_add_f32_dpp v20, v39, v20 quad_perm:[3,3,3,3] row_mask:0xf bank_mask:0xf
  v_add_f32 v19, v19, v20
  v_cvt_pk_bf16_f32 v19, 0, v19
  v_mul_f32 v19, 0x3d93cd3a, v19
  v_cvt_pk_bf16_f32 v19, 0, v19
  v_max_f32 v17, v17, v19
  ds_write_b32 v15, v19 offset:1472
  v_mfma_f32_16x16x32_bf16 v[36:39], v[184:187], v[24:27], 0
  v_mfma_f32_16x16x32_bf16 v[36:39], v[188:191], v[28:31], v[36:39]
  v_mfma_f32_16x16x32_bf16 v[36:39], v[192:195], v[32:35], v[36:39]
  s_mul_i32 s62, s59, 12288
  s_add_u32 s62, s62, s61
  s_waitcnt vmcnt(7)
  buffer_load_dwordx4 v[184:187], v2, s[28:31], s62 offen offset:0 nt
  s_waitcnt vmcnt(7)
  buffer_load_dwordx4 v[188:191], v2, s[28:31], s62 offen offset:256 nt
  s_waitcnt vmcnt(7)
  buffer_load_dwordx4 v[192:195], v2, s[28:31], s62 offen offset:512 nt
  s_add_u32 s59, s59, 1
  s_and_b32 s59, s59, 63
  s_add_u32 s62, s64, 112640
  s_waitcnt vmcnt(7)
  buffer_load_dwordx4 a[236:239], v7, s[40:43], s62 offen offset:1024
  v_mov_b32_dpp v19, v36 quad_perm:[0,0,0,0] row_mask:0xf bank_mask:0xf
  v_mov_b32_dpp v20, v38 quad_perm:[2,2,2,2] row_mask:0xf bank_mask:0xf
  s_nop 0
  v_add_f32_dpp v19, v37, v19 quad_perm:[1,1,1,1] row_mask:0xf bank_mask:0xf
  v_add_f32_dpp v20, v39, v20 quad_perm:[3,3,3,3] row_mask:0xf bank_mask:0xf
  v_add_f32 v19, v19, v20
  v_cvt_pk_bf16_f32 v19, 0, v19
  v_mul_f32 v19, 0x3d93cd3a, v19
  v_cvt_pk_bf16_f32 v19, 0, v19
  v_max_f32 v17, v17, v19
  ds_write_b32 v15, v19 offset:1504
  v_mfma_f32_16x16x32_bf16 v[36:39], v[196:199], v[24:27], 0
  v_mfma_f32_16x16x32_bf16 v[36:39], v[200:203], v[28:31], v[36:39]
  v_mfma_f32_16x16x32_bf16 v[36:39], v[204:207], v[32:35], v[36:39]
  s_mul_i32 s62, s59, 12288
  s_add_u32 s62, s62, s61
  s_waitcnt vmcnt(7)
  buffer_load_dwordx4 v[196:199], v2, s[28:31], s62 offen offset:0 nt
  s_waitcnt vmcnt(7)
  buffer_load_dwordx4 v[200:203], v2, s[28:31], s62 offen offset:256 nt
  s_waitcnt vmcnt(7)
  buffer_load_dwordx4 v[204:207], v2, s[28:31], s62 offen offset:512 nt
  s_add_u32 s59, s59, 1
  s_and_b32 s59, s59, 63
  s_add_u32 s62, s64, 0
  s_waitcnt vmcnt(7)
  buffer_load_dwordx4 a[0:3], v7, s[40:43], s62 offen offset:0
  v_mov_b32_dpp v19, v36 quad_perm:[0,0,0,0] row_mask:0xf bank_mask:0xf
  v_mov_b32_dpp v20, v38 quad_perm:[2,2,2,2] row_mask:0xf bank_mask:0xf
  s_nop 0
  v_add_f32_dpp v19, v37, v19 quad_perm:[1,1,1,1] row_mask:0xf bank_mask:0xf
  v_add_f32_dpp v20, v39, v20 quad_perm:[3,3,3,3] row_mask:0xf bank_mask:0xf
  v_add_f32 v19, v19, v20
  v_cvt_pk_bf16_f32 v19, 0, v19
  v_mul_f32 v19, 0x3d93cd3a, v19
  v_cvt_pk_bf16_f32 v19, 0, v19
  v_max_f32 v17, v17, v19
  ds_write_b32 v15, v19 offset:1536
  v_mfma_f32_16x16x32_bf16 v[36:39], v[208:211], v[24:27], 0
  v_mfma_f32_16x16x32_bf16 v[36:39], v[212:215], v[28:31], v[36:39]
  v_mfma_f32_16x16x32_bf16 v[36:39], v[216:219], v[32:35], v[36:39]
  s_mul_i32 s62, s59, 12288
  s_add_u32 s62, s62, s61
  s_waitcnt vmcnt(7)
  buffer_load_dwordx4 v[208:211], v2, s[28:31], s62 offen offset:0 nt
  s_waitcnt vmcnt(7)
  buffer_load_dwordx4 v[212:215], v2, s[28:31], s62 offen offset:256 nt
  s_waitcnt vmcnt(7)
  buffer_load_dwordx4 v[216:219], v2, s[28:31], s62 offen offset:512 nt
  s_add_u32 s59, s59, 1
  s_and_b32 s59, s59, 63
  s_add_u32 s62, s64, 10240
  s_waitcnt vmcnt(7)
  buffer_load_dwordx4 a[4:7], v7, s[40:43], s62 offen offset:0
  v_mov_b32_dpp v19, v36 quad_perm:[0,0,0,0] row_mask:0xf bank_mask:0xf
  v_mov_b32_dpp v20, v38 quad_perm:[2,2,2,2] row_mask:0xf bank_mask:0xf
  s_nop 0
  v_add_f32_dpp v19, v37, v19 quad_perm:[1,1,1,1] row_mask:0xf bank_mask:0xf
  v_add_f32_dpp v20, v39, v20 quad_perm:[3,3,3,3] row_mask:0xf bank_mask:0xf
  v_add_f32 v19, v19, v20
  v_cvt_pk_bf16_f32 v19, 0, v19
  v_mul_f32 v19, 0x3d93cd3a, v19
  v_cvt_pk_bf16_f32 v19, 0, v19
  v_max_f32 v17, v17, v19
  ds_write_b32 v15, v19 offset:1568
  v_mfma_f32_16x16x32_bf16 v[36:39], v[220:223], v[24:27], 0
  v_mfma_f32_16x16x32_bf16 v[36:39], v[224:227], v[28:31], v[36:39]
  v_mfma_f32_16x16x32_bf16 v[36:39], v[228:231], v[32:35], v[36:39]
  s_mul_i32 s62, s59, 12288
  s_add_u32 s62, s62, s61
  s_waitcnt vmcnt(7)
  buffer_load_dwordx4 v[220:223], v2, s[28:31], s62 offen offset:0 nt
  s_waitcnt vmcnt(7)
  buffer_load_dwordx4 v[224:227], v2, s[28:31], s62 offen offset:256 nt
  s_waitcnt vmcnt(7)
  buffer_load_dwordx4 v[228:231], v2, s[28:31], s62 offen offset:512 nt
  s_add_u32 s59, s59, 1
  s_and_b32 s59, s59, 63
  s_add_u32 s62, s64, 0
  s_waitcnt vmcnt(7)
  buffer_load_dwordx4 a[8:11], v7, s[40:43], s62 offen offset:256
  v_mov_b32_dpp v19, v36 quad_perm:[0,0,0,0] row_mask:0xf bank_mask:0xf
  v_mov_b32_dpp v20, v38 quad_perm:[2,2,2,2] row_mask:0xf bank_mask:0xf
  s_nop 0
  v_add_f32_dpp v19, v37, v19 quad_perm:[1,1,1,1] row_mask:0xf bank_mask:0xf
  v_add_f32_dpp v20, v39, v20 quad_perm:[3,3,3,3] row_mask:0xf bank_mask:0xf
  v_add_f32 v19, v19, v20
  v_cvt_pk_bf16_f32 v19, 0, v19
  v_mul_f32 v19, 0x3d93cd3a, v19
  v_cvt_pk_bf16_f32 v19, 0, v19
  v_max_f32 v17, v17, v19
  ds_write_b32 v15, v19 offset:1600
  v_mfma_f32_16x16x32_bf16 v[36:39], v[232:235], v[24:27], 0
  v_mfma_f32_16x16x32_bf16 v[36:39], v[236:239], v[28:31], v[36:39]
  v_mfma_f32_16x16x32_bf16 v[36:39], v[240:243], v[32:35], v[36:39]
  s_mul_i32 s62, s59, 12288
  s_add_u32 s62, s62, s61
  s_waitcnt vmcnt(7)
  buffer_load_dwordx4 v[232:235], v2, s[28:31], s62 offen offset:0 nt
  s_waitcnt vmcnt(7)
  buffer_load_dwordx4 v[236:239], v2, s[28:31], s62 offen offset:256 nt
  s_waitcnt vmcnt(7)
  buffer_load_dwordx4 v[240:243], v2, s[28:31], s62 offen offset:512 nt
  s_add_u32 s59, s59, 1
  s_and_b32 s59, s59, 63
  s_add_u32 s62, s64, 10240
  s_waitcnt vmcnt(7)
  buffer_load_dwordx4 a[12:15], v7, s[40:43], s62 offen offset:256
  v_mov_b32_dpp v19, v36 quad_perm:[0,0,0,0] row_mask:0xf bank_mask:0xf
  v_mov_b32_dpp v20, v38 quad_perm:[2,2,2,2] row_mask:0xf bank_mask:0xf
  s_nop 0
  v_add_f32_dpp v19, v37, v19 quad_perm:[1,1,1,1] row_mask:0xf bank_mask:0xf
  v_add_f32_dpp v20, v39, v20 quad_perm:[3,3,3,3] row_mask:0xf bank_mask:0xf
  v_add_f32 v19, v19, v20
  v_cvt_pk_bf16_f32 v19, 0, v19
  v_mul_f32 v19, 0x3d93cd3a, v19
  v_cvt_pk_bf16_f32 v19, 0, v19
  v_max_f32 v17, v17, v19
  ds_write_b32 v15, v19 offset:1632
  v_mfma_f32_16x16x32_bf16 v[36:39], v[100:103], v[24:27], 0
  v_mfma_f32_16x16x32_bf16 v[36:39], v[104:107], v[28:31], v[36:39]
  v_mfma_f32_16x16x32_bf16 v[36:39], v[108:111], v[32:35], v[36:39]
  s_mul_i32 s62, s60, 12288
  s_add_u32 s62, s62, s61
  s_waitcnt vmcnt(5)
  buffer_load_dwordx4 v[100:103], v3, s[32:35], s62 offen offset:0 nt
  s_waitcnt vmcnt(5)
  buffer_load_dwordx4 v[104:107], v3, s[32:35], s62 offen offset:256 nt
  s_waitcnt vmcnt(5)
  buffer_load_dwordx4 v[108:111], v3, s[32:35], s62 offen offset:512 nt
  s_add_u32 s60, s60, 1
  s_and_b32 s60, s60, 63
  s_add_u32 s62, s64, 0
  s_waitcnt vmcnt(5)
  buffer_load_dwordx4 a[16:19], v7, s[40:43], s62 offen offset:512
  v_mov_b32_dpp v19, v36 quad_perm:[0,0,0,0] row_mask:0xf bank_mask:0xf
  v_mov_b32_dpp v20, v38 quad_perm:[2,2,2,2] row_mask:0xf bank_mask:0xf
  s_nop 0
  v_add_f32_dpp v19, v37, v19 quad_perm:[1,1,1,1] row_mask:0xf bank_mask:0xf
  v_add_f32_dpp v20, v39, v20 quad_perm:[3,3,3,3] row_mask:0xf bank_mask:0xf
  v_add_f32 v19, v19, v20
  v_cvt_pk_bf16_f32 v19, 0, v19
  v_mul_f32 v19, 0x3d93cd3a, v19
  v_cvt_pk_bf16_f32 v19, 0, v19
  v_max_f32 v17, v17, v19
  ds_write_b32 v15, v19 offset:1664
  v_mfma_f32_16x16x32_bf16 v[36:39], v[112:115], v[24:27], 0
  v_mfma_f32_16x16x32_bf16 v[36:39], v[116:119], v[28:31], v[36:39]
  v_mfma_f32_16x16x32_bf16 v[36:39], v[120:123], v[32:35], v[36:39]
  s_mul_i32 s62, s60, 12288
  s_add_u32 s62, s62, s61
  s_waitcnt vmcnt(5)
  buffer_load_dwordx4 v[112:115], v3, s[32:35], s62 offen offset:0 nt
  s_waitcnt vmcnt(5)
  buffer_load_dwordx4 v[116:119], v3, s[32:35], s62 offen offset:256 nt
  s_waitcnt vmcnt(5)
  buffer_load_dwordx4 v[120:123], v3, s[32:35], s62 offen offset:512 nt
  s_add_u32 s60, s60, 1
  s_and_b32 s60, s60, 63
  s_add_u32 s62, s64, 10240
  s_waitcnt vmcnt(5)
  buffer_load_dwordx4 a[20:23], v7, s[40:43], s62 offen offset:512
  v_mov_b32_dpp v19, v36 quad_perm:[0,0,0,0] row_mask:0xf bank_mask:0xf
  v_mov_b32_dpp v20, v38 quad_perm:[2,2,2,2] row_mask:0xf bank_mask:0xf
  s_nop 0
  v_add_f32_dpp v19, v37, v19 quad_perm:[1,1,1,1] row_mask:0xf bank_mask:0xf
  v_add_f32_dpp v20, v39, v20 quad_perm:[3,3,3,3] row_mask:0xf bank_mask:0xf
  v_add_f32 v19, v19, v20
  v_cvt_pk_bf16_f32 v19, 0, v19
  v_mul_f32 v19, 0x3d93cd3a, v19
  v_cvt_pk_bf16_f32 v19, 0, v19
  v_max_f32 v17, v17, v19
  ds_write_b32 v15, v19 offset:1696
  v_mfma_f32_16x16x32_bf16 v[36:39], v[124:127], v[24:27], 0
  v_mfma_f32_16x16x32_bf16 v[36:39], v[128:131], v[28:31], v[36:39]
  v_mfma_f32_16x16x32_bf16 v[36:39], v[132:135], v[32:35], v[36:39]
  s_mul_i32 s62, s60, 12288
  s_add_u32 s62, s62, s61
  s_waitcnt vmcnt(5)
  buffer_load_dwordx4 v[124:127], v3, s[32:35], s62 offen offset:0 nt
  s_waitcnt vmcnt(5)
  buffer_load_dwordx4 v[128:131], v3, s[32:35], s62 offen offset:256 nt
  s_waitcnt vmcnt(5)
  buffer_load_dwordx4 v[132:135], v3, s[32:35], s62 offen offset:512 nt
  s_add_u32 s60, s60, 1
  s_and_b32 s60, s60, 63
  s_add_u32 s62, s64, 0
  s_waitcnt vmcnt(5)
  buffer_load_dwordx4 a[24:27], v7, s[40:43], s62 offen offset:768
  v_mov_b32_dpp v19, v36 quad_perm:[0,0,0,0] row_mask:0xf bank_mask:0xf
  v_mov_b32_dpp v20, v38 quad_perm:[2,2,2,2] row_mask:0xf bank_mask:0xf
  s_nop 0
  v_add_f32_dpp v19, v37, v19 quad_perm:[1,1,1,1] row_mask:0xf bank_mask:0xf
  v_add_f32_dpp v20, v39, v20 quad_perm:[3,3,3,3] row_mask:0xf bank_mask:0xf
  v_add_f32 v19, v19, v20
  v_cvt_pk_bf16_f32 v19, 0, v19
  v_mul_f32 v19, 0x3d93cd3a, v19
  v_cvt_pk_bf16_f32 v19, 0, v19
  v_max_f32 v17, v17, v19
  ds_write_b32 v15, v19 offset:1728
  v_mfma_f32_16x16x32_bf16 v[36:39], v[136:139], v[24:27], 0
  v_mfma_f32_16x16x32_bf16 v[36:39], v[140:143], v[28:31], v[36:39]
  v_mfma_f32_16x16x32_bf16 v[36:39], v[144:147], v[32:35], v[36:39]
  s_mul_i32 s62, s60, 12288
  s_add_u32 s62, s62, s61
  s_waitcnt vmcnt(5)
  buffer_load_dwordx4 v[136:139], v3, s[32:35], s62 offen offset:0 nt
  s_waitcnt vmcnt(5)
  buffer_load_dwordx4 v[140:143], v3, s[32:35], s62 offen offset:256 nt
  s_waitcnt vmcnt(5)
  buffer_load_dwordx4 v[144:147], v3, s[32:35], s62 offen offset:512 nt
  s_add_u32 s60, s60, 1
  s_and_b32 s60, s60, 63
  s_add_u32 s62, s64, 10240
  s_waitcnt vmcnt(5)
  buffer_load_dwordx4 a[28:31], v7, s[40:43], s62 offen offset:768
  v_mov_b32_dpp v19, v36 quad_perm:[0,0,0,0] row_mask:0xf bank_mask:0xf
  v_mov_b32_dpp v20, v38 quad_perm:[2,2,2,2] row_mask:0xf bank_mask:0xf
  s_nop 0
  v_add_f32_dpp v19, v37, v19 quad_perm:[1,1,1,1] row_mask:0xf bank_mask:0xf
  v_add_f32_dpp v20, v39, v20 quad_perm:[3,3,3,3] row_mask:0xf bank_mask:0xf
  v_add_f32 v19, v19, v20
  v_cvt_pk_bf16_f32 v19, 0, v19
  v_mul_f32 v19, 0x3d93cd3a, v19
  v_cvt_pk_bf16_f32 v19, 0, v19
  v_max_f32 v17, v17, v19
  ds_write_b32 v15, v19 offset:1760
  v_mfma_f32_16x16x32_bf16 v[36:39], v[148:151], v[24:27], 0
  v_mfma_f32_16x16x32_bf16 v[36:39], v[152:155], v[28:31], v[36:39]
  v_mfma_f32_16x16x32_bf16 v[36:39], v[156:159], v[32:35], v[36:39]
  s_mul_i32 s62, s60, 12288
  s_add_u32 s62, s62, s61
  s_waitcnt vmcnt(5)
  buffer_load_dwordx4 v[148:151], v3, s[32:35], s62 offen offset:0 nt
  s_waitcnt vmcnt(5)
  buffer_load_dwordx4 v[152:155], v3, s[32:35], s62 offen offset:256 nt
  s_waitcnt vmcnt(5)
  buffer_load_dwordx4 v[156:159], v3, s[32:35], s62 offen offset:512 nt
  s_add_u32 s60, s60, 1
  s_and_b32 s60, s60, 63
  s_add_u32 s62, s64, 0
  s_waitcnt vmcnt(5)
  buffer_load_dwordx4 a[32:35], v7, s[40:43], s62 offen offset:1024
  v_mov_b32_dpp v19, v36 quad_perm:[0,0,0,0] row_mask:0xf bank_mask:0xf
  v_mov_b32_dpp v20, v38 quad_perm:[2,2,2,2] row_mask:0xf bank_mask:0xf
  s_nop 0
  v_add_f32_dpp v19, v37, v19 quad_perm:[1,1,1,1] row_mask:0xf bank_mask:0xf
  v_add_f32_dpp v20, v39, v20 quad_perm:[3,3,3,3] row_mask:0xf bank_mask:0xf
  v_add_f32 v19, v19, v20
  v_cvt_pk_bf16_f32 v19, 0, v19
  v_mul_f32 v19, 0x3d93cd3a, v19
  v_cvt_pk_bf16_f32 v19, 0, v19
  v_max_f32 v17, v17, v19
  ds_write_b32 v15, v19 offset:1792
  v_mfma_f32_16x16x32_bf16 v[36:39], v[160:163], v[24:27], 0
  v_mfma_f32_16x16x32_bf16 v[36:39], v[164:167], v[28:31], v[36:39]
  v_mfma_f32_16x16x32_bf16 v[36:39], v[168:171], v[32:35], v[36:39]
  s_mul_i32 s62, s60, 12288
  s_add_u32 s62, s62, s61
  s_waitcnt vmcnt(5)
  buffer_load_dwordx4 v[160:163], v3, s[32:35], s62 offen offset:0 nt
  s_waitcnt vmcnt(5)
  buffer_load_dwordx4 v[164:167], v3, s[32:35], s62 offen offset:256 nt
  s_waitcnt vmcnt(5)
  buffer_load_dwordx4 v[168:171], v3, s[32:35], s62 offen offset:512 nt
  s_add_u32 s60, s60, 1
  s_and_b32 s60, s60, 63
  s_add_u32 s62, s64, 10240
  s_waitcnt vmcnt(5)
  buffer_load_dwordx4 a[36:39], v7, s[40:43], s62 offen offset:1024
  v_mov_b32_dpp v19, v36 quad_perm:[0,0,0,0] row_mask:0xf bank_mask:0xf
  v_mov_b32_dpp v20, v38 quad_perm:[2,2,2,2] row_mask:0xf bank_mask:0xf
  s_nop 0
  v_add_f32_dpp v19, v37, v19 quad_perm:[1,1,1,1] row_mask:0xf bank_mask:0xf
  v_add_f32_dpp v20, v39, v20 quad_perm:[3,3,3,3] row_mask:0xf bank_mask:0xf
  v_add_f32 v19, v19, v20
  v_cvt_pk_bf16_f32 v19, 0, v19
  v_mul_f32 v19, 0x3d93cd3a, v19
  v_cvt_pk_bf16_f32 v19, 0, v19
  v_max_f32 v17, v17, v19
  ds_write_b32 v15, v19 offset:1824
  v_mfma_f32_16x16x32_bf16 v[36:39], v[172:175], v[24:27], 0
  v_mfma_f32_16x16x32_bf16 v[36:39], v[176:179], v[28:31], v[36:39]
  v_mfma_f32_16x16x32_bf16 v[36:39], v[180:183], v[32:35], v[36:39]
  s_mul_i32 s62, s60, 12288
  s_add_u32 s62, s62, s61
  s_waitcnt vmcnt(5)
  buffer_load_dwordx4 v[172:175], v3, s[32:35], s62 offen offset:0 nt
  s_waitcnt vmcnt(5)
  buffer_load_dwordx4 v[176:179], v3, s[32:35], s62 offen offset:256 nt
  s_waitcnt vmcnt(5)
  buffer_load_dwordx4 v[180:183], v3, s[32:35], s62 offen offset:512 nt
  s_add_u32 s60, s60, 1
  s_and_b32 s60, s60, 63
  s_add_u32 s62, s64, 20480
  s_waitcnt vmcnt(5)
  buffer_load_dwordx4 a[40:43], v7, s[40:43], s62 offen offset:0
  v_mov_b32_dpp v19, v36 quad_perm:[0,0,0,0] row_mask:0xf bank_mask:0xf
  v_mov_b32_dpp v20, v38 quad_perm:[2,2,2,2] row_mask:0xf bank_mask:0xf
  s_nop 0
  v_add_f32_dpp v19, v37, v19 quad_perm:[1,1,1,1] row_mask:0xf bank_mask:0xf
  v_add_f32_dpp v20, v39, v20 quad_perm:[3,3,3,3] row_mask:0xf bank_mask:0xf
  v_add_f32 v19, v19, v20
  v_cvt_pk_bf16_f32 v19, 0, v19
  v_mul_f32 v19, 0x3d93cd3a, v19
  v_cvt_pk_bf16_f32 v19, 0, v19
  v_max_f32 v17, v17, v19
  ds_write_b32 v15, v19 offset:1856
  v_mfma_f32_16x16x32_bf16 v[36:39], v[184:187], v[24:27], 0
  v_mfma_f32_16x16x32_bf16 v[36:39], v[188:191], v[28:31], v[36:39]
  v_mfma_f32_16x16x32_bf16 v[36:39], v[192:195], v[32:35], v[36:39]
  s_mul_i32 s62, s60, 12288
  s_add_u32 s62, s62, s61
  s_waitcnt vmcnt(5)
  buffer_load_dwordx4 v[184:187], v3, s[32:35], s62 offen offset:0 nt
  s_waitcnt vmcnt(5)
  buffer_load_dwordx4 v[188:191], v3, s[32:35], s62 offen offset:256 nt
  s_waitcnt vmcnt(5)
  buffer_load_dwordx4 v[192:195], v3, s[32:35], s62 offen offset:512 nt
  s_add_u32 s60, s60, 1
  s_and_b32 s60, s60, 63
  s_add_u32 s62, s64, 30720
  s_waitcnt vmcnt(5)
  buffer_load_dwordx4 a[44:47], v7, s[40:43], s62 offen offset:0
  v_mov_b32_dpp v19, v36 quad_perm:[0,0,0,0] row_mask:0xf bank_mask:0xf
  v_mov_b32_dpp v20, v38 quad_perm:[2,2,2,2] row_mask:0xf bank_mask:0xf
  s_nop 0
  v_add_f32_dpp v19, v37, v19 quad_perm:[1,1,1,1] row_mask:0xf bank_mask:0xf
  v_add_f32_dpp v20, v39, v20 quad_perm:[3,3,3,3] row_mask:0xf bank_mask:0xf
  v_add_f32 v19, v19, v20
  v_cvt_pk_bf16_f32 v19, 0, v19
  v_mul_f32 v19, 0x3d93cd3a, v19
  v_cvt_pk_bf16_f32 v19, 0, v19
  v_max_f32 v17, v17, v19
  ds_write_b32 v15, v19 offset:1888
  v_mfma_f32_16x16x32_bf16 v[36:39], v[196:199], v[24:27], 0
  v_mfma_f32_16x16x32_bf16 v[36:39], v[200:203], v[28:31], v[36:39]
  v_mfma_f32_16x16x32_bf16 v[36:39], v[204:207], v[32:35], v[36:39]
  s_mul_i32 s62, s60, 12288
  s_add_u32 s62, s62, s61
  s_waitcnt vmcnt(5)
  buffer_load_dwordx4 v[196:199], v3, s[32:35], s62 offen offset:0 nt
  s_waitcnt vmcnt(5)
  buffer_load_dwordx4 v[200:203], v3, s[32:35], s62 offen offset:256 nt
  s_waitcnt vmcnt(5)
  buffer_load_dwordx4 v[204:207], v3, s[32:35], s62 offen offset:512 nt
  s_add_u32 s60, s60, 1
  s_and_b32 s60, s60, 63
  s_nop 0
  v_mov_b32_dpp v19, v36 quad_perm:[0,0,0,0] row_mask:0xf bank_mask:0xf
  v_mov_b32_dpp v20, v38 quad_perm:[2,2,2,2] row_mask:0xf bank_mask:0xf
  s_nop 0
  v_add_f32_dpp v19, v37, v19 quad_perm:[1,1,1,1] row_mask:0xf bank_mask:0xf
  v_add_f32_dpp v20, v39, v20 quad_perm:[3,3,3,3] row_mask:0xf bank_mask:0xf
  v_add_f32 v19, v19, v20
  v_cvt_pk_bf16_f32 v19, 0, v19
  v_mul_f32 v19, 0x3d93cd3a, v19
  v_cvt_pk_bf16_f32 v19, 0, v19
  v_max_f32 v17, v17, v19
  ds_write_b32 v15, v19 offset:1920
  v_mfma_f32_16x16x32_bf16 v[36:39], v[208:211], v[24:27], 0
  v_mfma_f32_16x16x32_bf16 v[36:39], v[212:215], v[28:31], v[36:39]
  v_mfma_f32_16x16x32_bf16 v[36:39], v[216:219], v[32:35], v[36:39]
  s_mul_i32 s62, s60, 12288
  s_add_u32 s62, s62, s61
  s_waitcnt vmcnt(5)
  buffer_load_dwordx4 v[208:211], v3, s[32:35], s62 offen offset:0 nt
  s_waitcnt vmcnt(5)
  buffer_load_dwordx4 v[212:215], v3, s[32:35], s62 offen offset:256 nt
  s_waitcnt vmcnt(5)
  buffer_load_dwordx4 v[216:219], v3, s[32:35], s62 offen offset:512 nt
  s_add_u32 s60, s60, 1
  s_and_b32 s60, s60, 63
  s_nop 0
  v_mov_b32_dpp v19, v36 quad_perm:[0,0,0,0] row_mask:0xf bank_mask:0xf
  v_mov_b32_dpp v20, v38 quad_perm:[2,2,2,2] row_mask:0xf bank_mask:0xf
  s_nop 0
  v_add_f32_dpp v19, v37, v19 quad_perm:[1,1,1,1] row_mask:0xf bank_mask:0xf
  v_add_f32_dpp v20, v39, v20 quad_perm:[3,3,3,3] row_mask:0xf bank_mask:0xf
  v_add_f32 v19, v19, v20
  v_cvt_pk_bf16_f32 v19, 0, v19
  v_mul_f32 v19, 0x3d93cd3a, v19
  v_cvt_pk_bf16_f32 v19, 0, v19
  v_max_f32 v17, v17, v19
  ds_write_b32 v15, v19 offset:1952
  v_mfma_f32_16x16x32_bf16 v[36:39], v[220:223], v[24:27], 0
  v_mfma_f32_16x16x32_bf16 v[36:39], v[224:227], v[28:31], v[36:39]
  v_mfma_f32_16x16x32_bf16 v[36:39], v[228:231], v[32:35], v[36:39]
  s_mul_i32 s62, s60, 12288
  s_add_u32 s62, s62, s61
  s_waitcnt vmcnt(5)
  buffer_load_dwordx4 v[220:223], v3, s[32:35], s62 offen offset:0 nt
  s_waitcnt vmcnt(5)
  buffer_load_dwordx4 v[224:227], v3, s[32:35], s62 offen offset:256 nt
  s_waitcnt vmcnt(5)
  buffer_load_dwordx4 v[228:231], v3, s[32:35], s62 offen offset:512 nt
  s_add_u32 s60, s60, 1
  s_and_b32 s60, s60, 63
  s_nop 0
  v_mov_b32_dpp v19, v36 quad_perm:[0,0,0,0] row_mask:0xf bank_mask:0xf
  v_mov_b32_dpp v20, v38 quad_perm:[2,2,2,2] row_mask:0xf bank_mask:0xf
  s_nop 0
  v_add_f32_dpp v19, v37, v19 quad_perm:[1,1,1,1] row_mask:0xf bank_mask:0xf
  v_add_f32_dpp v20, v39, v20 quad_perm:[3,3,3,3] row_mask:0xf bank_mask:0xf
  v_add_f32 v19, v19, v20
  v_cvt_pk_bf16_f32 v19, 0, v19
  v_mul_f32 v19, 0x3d93cd3a, v19
  v_cvt_pk_bf16_f32 v19, 0, v19
  v_max_f32 v17, v17, v19
  ds_write_b32 v15, v19 offset:1984
  v_mfma_f32_16x16x32_bf16 v[36:39], v[232:235], v[24:27], 0
  v_mfma_f32_16x16x32_bf16 v[36:39], v[236:239], v[28:31], v[36:39]
  v_mfma_f32_16x16x32_bf16 v[36:39], v[240:243], v[32:35], v[36:39]
  s_mul_i32 s62, s60, 12288
  s_add_u32 s62, s62, s61
  s_waitcnt vmcnt(5)
  buffer_load_dwordx4 v[232:235], v3, s[32:35], s62 offen offset:0 nt
  s_waitcnt vmcnt(5)
  buffer_load_dwordx4 v[236:239], v3, s[32:35], s62 offen offset:256 nt
  s_waitcnt vmcnt(5)
  buffer_load_dwordx4 v[240:243], v3, s[32:35], s62 offen offset:512 nt
  s_add_u32 s60, s60, 1
  s_and_b32 s60, s60, 63
  s_nop 0
  v_mov_b32_dpp v19, v36 quad_perm:[0,0,0,0] row_mask:0xf bank_mask:0xf
  v_mov_b32_dpp v20, v38 quad_perm:[2,2,2,2] row_mask:0xf bank_mask:0xf
  s_nop 0
  v_add_f32_dpp v19, v37, v19 quad_perm:[1,1,1,1] row_mask:0xf bank_mask:0xf
  v_add_f32_dpp v20, v39, v20 quad_perm:[3,3,3,3] row_mask:0xf bank_mask:0xf
  v_add_f32 v19, v19, v20
  v_cvt_pk_bf16_f32 v19, 0, v19
  v_mul_f32 v19, 0x3d93cd3a, v19
  v_cvt_pk_bf16_f32 v19, 0, v19
  v_max_f32 v17, v17, v19
  ds_write_b32 v15, v19 offset:2016
  s_nop 1
  v_max_f32_dpp v17, v17, v17 quad_perm:[1,0,3,2] row_mask:0xf bank_mask:0xf
  s_nop 1
  v_max_f32_dpp v17, v17, v17 quad_perm:[2,3,0,1] row_mask:0xf bank_mask:0xf
  s_nop 1
  v_max_f32_dpp v17, v17, v17 row_half_mirror row_mask:0xf bank_mask:0xf
  s_nop 1
  v_max_f32_dpp v17, v17, v17 row_mirror row_mask:0xf bank_mask:0xf
  s_nop 1
  v_max_f32_dpp v17, v17, v17 row_bcast:15 row_mask:0xa bank_mask:0xf
  s_nop 1
  v_max_f32_dpp v17, v17, v17 row_bcast:31 row_mask:0xc bank_mask:0xf
  s_nop 0
  v_readlane_b32 s65, v17, 63
  s_nop 1
  s_lshl_b32 s57, s52, 11
  s_add_u32 s57, s57, 47488
  v_lshl_add_u32 v19, v1, 5, s57
  s_waitcnt lgkmcnt(0)
  ds_read_b128 v[52:55], v19
  ds_read_b128 v[56:59], v19 offset:16
  s_waitcnt lgkmcnt(0)
  v_subrev_f32 v52, s65, v52
  v_subrev_f32 v53, s65, v53
  v_subrev_f32 v54, s65, v54
  v_subrev_f32 v55, s65, v55
  v_subrev_f32 v56, s65, v56
  v_subrev_f32 v57, s65, v57
  v_subrev_f32 v58, s65, v58
  v_subrev_f32 v59, s65, v59
  v_mul_f32 v52, 0x3fb8aa3b, v52
  v_mul_f32 v53, 0x3fb8aa3b, v53
  v_mul_f32 v54, 0x3fb8aa3b, v54
  v_mul_f32 v55, 0x3fb8aa3b, v55
  v_mul_f32 v56, 0x3fb8aa3b, v56
  v_mul_f32 v57, 0x3fb8aa3b, v57
  v_mul_f32 v58, 0x3fb8aa3b, v58
  v_mul_f32 v59, 0x3fb8aa3b, v59
  v_exp_f32 v52, v52
  v_exp_f32 v53, v53
  v_exp_f32 v54, v54
  v_exp_f32 v55, v55
  v_exp_f32 v56, v56
  v_exp_f32 v57, v57
  v_exp_f32 v58, v58
  v_exp_f32 v59, v59
  s_nop 0
  v_add_f32 v20, v52, v53
  v_add_f32 v20, v20, v54
  v_add_f32 v20, v20, v55
  v_add_f32 v20, v20, v56
  v_add_f32 v20, v20, v57
  v_add_f32 v20, v20, v58
  v_add_f32 v20, v20, v59
  v_cvt_pk_bf16_f32 v52, v52, v52
  v_cvt_pk_bf16_f32 v53, v53, v53
  v_cvt_pk_bf16_f32 v54, v54, v54
  v_cvt_pk_bf16_f32 v55, v55, v55
  v_cvt_pk_bf16_f32 v56, v56, v56
  v_cvt_pk_bf16_f32 v57, v57, v57
  v_cvt_pk_bf16_f32 v58, v58, v58
  v_cvt_pk_bf16_f32 v59, v59, v59
  ds_write_b128 v19, v[52:55]
  ds_write_b128 v19, v[56:59] offset:16
  s_nop 1
  v_add_f32_dpp v20, v20, v20 quad_perm:[1,0,3,2] row_mask:0xf bank_mask:0xf
  s_nop 1
  v_add_f32_dpp v20, v20, v20 quad_perm:[2,3,0,1] row_mask:0xf bank_mask:0xf
  s_nop 1
  v_add_f32_dpp v20, v20, v20 row_half_mirror row_mask:0xf bank_mask:0xf
  s_nop 1
  v_add_f32_dpp v20, v20, v20 row_mirror row_mask:0xf bank_mask:0xf
  s_nop 1
  v_add_f32_dpp v20, v20, v20 row_bcast:15 row_mask:0xa bank_mask:0xf
  s_nop 1
  v_add_f32_dpp v20, v20, v20 row_bcast:31 row_mask:0xc bank_mask:0xf
  s_nop 0
  v_readlane_b32 s66, v20, 63
  s_nop 1
  v_mov_b32 v60, s65
  v_mov_b32 v61, s66
  v_mov_b32 v62, s48
  v_mov_b32 v63, s48
  s_lshl_b32 s57, s56, 7
  s_add_u32 s57, s57, 49152
  v_lshl_add_u32 v18, v1, 4, s57
  s_mov_b32 s57, 45312
  v_writelane_b32 v18, s57, 8
  s_lshl_b32 s58, s52, 4
  v_mov_b32 v19, s58
  v_mov_b32 v20, 1
  s_mov_b64 exec, 1
  ds_write_b128 v19, v[60:63] offset:37056
  s_waitcnt lgkmcnt(0)
  ds_add_rtn_u32 v20, v23, v20 offset:37120
  s_waitcnt lgkmcnt(0)
  v_readfirstlane_b32 s57, v20
  s_mov_b32 exec_lo, 0x000000ff
  s_mov_b32 exec_hi, 0x00000000
  s_cmp_lg_u32 s57, 3
  s_cbranch_scc1 L_nopub
  v_lshlrev_b32 v19, 3, v1
  v_lshlrev_b32 v20, 4, v1
  ds_read_b64 v[60:61], v19 offset:36992
  ds_read_b128 v[64:67], v20 offset:37056
  s_lshl_b32 s57, s2, 7
  s_add_u32 s57, s57, 65536
  s_lshl_b32 s58, s55, 6
  s_waitcnt lgkmcnt(0)
  buffer_store_dwordx4 v[60:63], v20, s[44:47], s57 offen sc1 nt
  s_mov_b64 exec, 15
  buffer_store_dwordx4 v[64:67], v18, s[44:47], s58 offen sc1 nt
L_nopub:
  s_mov_b64 exec, -1
  s_waitcnt lgkmcnt(0)
  ds_read_b32 v24, v15 offset:0
  ds_read_b32 v25, v15 offset:32
  ds_read_b32 v26, v15 offset:64
  ds_read_b32 v27, v15 offset:96
  ds_read_b32 v28, v15 offset:128
  s_waitcnt lgkmcnt(4)
  v_and_b32 v52, v24, v8
  v_and_b32 v53, v24, v9
  v_and_b32 v54, v24, v10
  v_and_b32 v55, v24, v11
  s_nop 1
  v_mfma_f32_16x16x32_bf16 v[40:43], v[100:103], v[52:55], v[40:43]
  v_mfma_f32_16x16x32_bf16 v[44:47], v[104:107], v[52:55], v[44:47]
  v_mfma_f32_16x16x32_bf16 v[48:51], v[108:111], v[52:55], v[48:51]
  s_mul_i32 s62, s60, 12288
  s_add_u32 s62, s62, s61
  s_waitcnt vmcnt(5)
  buffer_load_dwordx4 v[100:103], v3, s[32:35], s62 offen offset:0 nt
  s_waitcnt vmcnt(5)
  buffer_load_dwordx4 v[104:107], v3, s[32:35], s62 offen offset:256 nt
  s_waitcnt vmcnt(5)
  buffer_load_dwordx4 v[108:111], v3, s[32:35], s62 offen offset:512 nt
  s_add_u32 s60, s60, 1
  s_and_b32 s60, s60, 63
  ds_read_b32 v29, v15 offset:160
  s_waitcnt lgkmcnt(4)
  v_and_b32 v56, v25, v8
  v_and_b32 v57, v25, v9
  v_and_b32 v58, v25, v10
  v_and_b32 v59, v25, v11
  s_nop 1
  v_mfma_f32_16x16x32_bf16 v[40:43], v[112:115], v[56:59], v[40:43]
  v_mfma_f32_16x16x32_bf16 v[44:47], v[116:119], v[56:59], v[44:47]
  v_mfma_f32_16x16x32_bf16 v[48:51], v[120:123], v[56:59], v[48:51]
  s_mul_i32 s62, s60, 12288
  s_add_u32 s62, s62, s61
  s_waitcnt vmcnt(5)
  buffer_load_dwordx4 v[112:115], v3, s[32:35], s62 offen offset:0 nt
  s_waitcnt vmcnt(5)
  buffer_load_dwordx4 v[116:119], v3, s[32:35], s62 offen offset:256 nt
  s_waitcnt vmcnt(5)
  buffer_load_dwordx4 v[120:123], v3, s[32:35], s62 offen offset:512 nt
  s_add_u32 s60, s60, 1
  s_and_b32 s60, s60, 63
  ds_read_b32 v30, v15 offset:192
  s_waitcnt lgkmcnt(4)
  v_and_b32 v52, v26, v8
  v_and_b32 v53, v26, v9
  v_and_b32 v54, v26, v10
  v_and_b32 v55, v26, v11
  s_nop 1
  v_mfma_f32_16x16x32_bf16 v[40:43], v[124:127], v[52:55], v[40:43]
  v_mfma_f32_16x16x32_bf16 v[44:47], v[128:131], v[52:55], v[44:47]
  v_mfma_f32_16x16x32_bf16 v[48:51], v[132:135], v[52:55], v[48:51]
  s_mul_i32 s62, s60, 12288
  s_add_u32 s62, s62, s61
  s_waitcnt vmcnt(5)
  buffer_load_dwordx4 v[124:127], v3, s[32:35], s62 offen offset:0 nt
  s_waitcnt vmcnt(5)
  buffer_load_dwordx4 v[128:131], v3, s[32:35], s62 offen offset:256 nt
  s_waitcnt vmcnt(5)
  buffer_load_dwordx4 v[132:135], v3, s[32:35], s62 offen offset:512 nt
  s_add_u32 s60, s60, 1
  s_and_b32 s60, s60, 63
  ds_read_b32 v31, v15 offset:224
  s_waitcnt lgkmcnt(4)
  v_and_b32 v56, v27, v8
  v_and_b32 v57, v27, v9
  v_and_b32 v58, v27, v10
  v_and_b32 v59, v27, v11
  s_nop 1
  v_mfma_f32_16x16x32_bf16 v[40:43], v[136:139], v[56:59], v[40:43]
  v_mfma_f32_16x16x32_bf16 v[44:47], v[140:143], v[56:59], v[44:47]
  v_mfma_f32_16x16x32_bf16 v[48:51], v[144:147], v[56:59], v[48:51]
  s_mul_i32 s62, s60, 12288
  s_add_u32 s62, s62, s61
  s_waitcnt vmcnt(5)
  buffer_load_dwordx4 v[136:139], v3, s[32:35], s62 offen offset:0 nt
  s_waitcnt vmcnt(5)
  buffer_load_dwordx4 v[140:143], v3, s[32:35], s62 offen offset:256 nt
  s_waitcnt vmcnt(5)
  buffer_load_dwordx4 v[144:147], v3, s[32:35], s62 offen offset:512 nt
  s_add_u32 s60, s60, 1
  s_and_b32 s60, s60, 63
  ds_read_b32 v24, v15 offset:256
  s_waitcnt lgkmcnt(4)
  v_and_b32 v52, v28, v8
  v_and_b32 v53, v28, v9
  v_and_b32 v54, v28, v10
  v_and_b32 v55, v28, v11
  s_nop 1
  v_mfma_f32_16x16x32_bf16 v[40:43], v[148:151], v[52:55], v[40:43]
  v_mfma_f32_16x16x32_bf16 v[44:47], v[152:155], v[52:55], v[44:47]
  v_mfma_f32_16x16x32_bf16 v[48:51], v[156:159], v[52:55], v[48:51]
  s_mul_i32 s62, s60, 12288
  s_add_u32 s62, s62, s61
  s_waitcnt vmcnt(5)
  buffer_load_dwordx4 v[148:151], v3, s[32:35], s62 offen offset:0 nt
  s_waitcnt vmcnt(5)
  buffer_load_dwordx4 v[152:155], v3, s[32:35], s62 offen offset:256 nt
  s_waitcnt vmcnt(5)
  buffer_load_dwordx4 v[156:159], v3, s[32:35], s62 offen offset:512 nt
  s_add_u32 s60, s60, 1
  s_and_b32 s60, s60, 63
  ds_read_b32 v25, v15 offset:288
  s_waitcnt lgkmcnt(4)
  v_and_b32 v56, v29, v8
  v_and_b32 v57, v29, v9
  v_and_b32 v58, v29, v10
  v_and_b32 v59, v29, v11
  s_nop 1
  v_mfma_f32_16x16x32_bf16 v[40:43], v[160:163], v[56:59], v[40:43]
  v_mfma_f32_16x16x32_bf16 v[44:47], v[164:167], v[56:59], v[44:47]
  v_mfma_f32_16x16x32_bf16 v[48:51], v[168:171], v[56:59], v[48:51]
  s_mul_i32 s62, s60, 12288
  s_add_u32 s62, s62, s61
  s_waitcnt vmcnt(5)
  buffer_load_dwordx4 v[160:163], v3, s[32:35], s62 offen offset:0 nt
  s_waitcnt vmcnt(5)
  buffer_load_dwordx4 v[164:167], v3, s[32:35], s62 offen offset:256 nt
  s_waitcnt vmcnt(5)
  buffer_load_dwordx4 v[168:171], v3, s[32:35], s62 offen offset:512 nt
  s_add_u32 s60, s60, 1
  s_and_b32 s60, s60, 63
  ds_read_b32 v26, v15 offset:320
  s_waitcnt lgkmcnt(4)
  v_and_b32 v52, v30, v8
  v_and_b32 v53, v30, v9
  v_and_b32 v54, v30, v10
  v_and_b32 v55, v30, v11
  s_nop 1
  v_mfma_f32_16x16x32_bf16 v[40:43], v[172:175], v[52:55], v[40:43]
  v_mfma_f32_16x16x32_bf16 v[44:47], v[176:179], v[52:55], v[44:47]
  v_mfma_f32_16x16x32_bf16 v[48:51], v[180:183], v[52:55], v[48:51]
  s_mul_i32 s62, s60, 12288
  s_add_u32 s62, s62, s61
  s_waitcnt vmcnt(5)
  buffer_load_dwordx4 v[172:175], v3, s[32:35], s62 offen offset:0 nt
  s_waitcnt vmcnt(5)
  buffer_load_dwordx4 v[176:179], v3, s[32:35], s62 offen offset:256 nt
  s_waitcnt vmcnt(5)
  buffer_load_dwordx4 v[180:183], v3, s[32:35], s62 offen offset:512 nt
  s_add_u32 s60, s60, 1
  s_and_b32 s60, s60, 63
  ds_read_b32 v27, v15 offset:352
  s_waitcnt lgkmcnt(4)
  v_and_b32 v56, v31, v8
  v_and_b32 v57, v31, v9
  v_and_b32 v58, v31, v10
  v_and_b32 v59, v31, v11
  s_nop 1
  v_mfma_f32_16x16x32_bf16 v[40:43], v[184:187], v[56:59], v[40:43]
  v_mfma_f32_16x16x32_bf16 v[44:47], v[188:191], v[56:59], v[44:47]
  v_mfma_f32_16x16x32_bf16 v[48:51], v[192:195], v[56:59], v[48:51]
  s_mul_i32 s62, s60, 12288
  s_add_u32 s62, s62, s61
  s_waitcnt vmcnt(5)
  buffer_load_dwordx4 v[184:187], v3, s[32:35], s62 offen offset:0 nt
  s_waitcnt vmcnt(5)
  buffer_load_dwordx4 v[188:191], v3, s[32:35], s62 offen offset:256 nt
  s_waitcnt vmcnt(5)
  buffer_load_dwordx4 v[192:195], v3, s[32:35], s62 offen offset:512 nt
  s_add_u32 s60, s60, 1
  s_and_b32 s60, s60, 63
  ds_read_b32 v28, v15 offset:384
  s_waitcnt lgkmcnt(4)
  v_and_b32 v52, v24, v8
  v_and_b32 v53, v24, v9
  v_and_b32 v54, v24, v10
  v_and_b32 v55, v24, v11
  s_nop 1
  v_mfma_f32_16x16x32_bf16 v[40:43], v[196:199], v[52:55], v[40:43]
  v_mfma_f32_16x16x32_bf16 v[44:47], v[200:203], v[52:55], v[44:47]
  v_mfma_f32_16x16x32_bf16 v[48:51], v[204:207], v[52:55], v[48:51]
  s_mul_i32 s62, s60, 12288
  s_add_u32 s62, s62, s61
  s_waitcnt vmcnt(5)
  buffer_load_dwordx4 v[196:199], v3, s[32:35], s62 offen offset:0 nt
  s_waitcnt vmcnt(5)
  buffer_load_dwordx4 v[200:203], v3, s[32:35], s62 offen offset:256 nt
  s_waitcnt vmcnt(5)
  buffer_load_dwordx4 v[204:207], v3, s[32:35], s62 offen offset:512 nt
  s_add_u32 s60, s60, 1
  s_and_b32 s60, s60, 63
  ds_read_b32 v29, v15 offset:416
  s_waitcnt lgkmcnt(4)
  v_and_b32 v56, v25, v8
  v_and_b32 v57, v25, v9
  v_and_b32 v58, v25, v10
  v_and_b32 v59, v25, v11
  s_nop 1
  v_mfma_f32_16x16x32_bf16 v[40:43], v[208:211], v[56:59], v[40:43]
  v_mfma_f32_16x16x32_bf16 v[44:47], v[212:215], v[56:59], v[44:47]
  v_mfma_f32_16x16x32_bf16 v[48:51], v[216:219], v[56:59], v[48:51]
  s_mul_i32 s62, s60, 12288
  s_add_u32 s62, s62, s61
  s_waitcnt vmcnt(5)
  buffer_load_dwordx4 v[208:211], v3, s[32:35], s62 offen offset:0 nt
  s_waitcnt vmcnt(5)
  buffer_load_dwordx4 v[212:215], v3, s[32:35], s62 offen offset:256 nt
  s_waitcnt vmcnt(5)
  buffer_load_dwordx4 v[216:219], v3, s[32:35], s62 offen offset:512 nt
  s_add_u32 s60, s60, 1
  s_and_b32 s60, s60, 63
  ds_read_b32 v30, v15 offset:448
  s_waitcnt lgkmcnt(4)
  v_and_b32 v52, v26, v8
  v_and_b32 v53, v26, v9
  v_and_b32 v54, v26, v10
  v_and_b32 v55, v26, v11
  s_nop 1
  v_mfma_f32_16x16x32_bf16 v[40:43], v[220:223], v[52:55], v[40:43]
  v_mfma_f32_16x16x32_bf16 v[44:47], v[224:227], v[52:55], v[44:47]
  v_mfma_f32_16x16x32_bf16 v[48:51], v[228:231], v[52:55], v[48:51]
  s_mul_i32 s62, s60, 12288
  s_add_u32 s62, s62, s61
  s_waitcnt vmcnt(5)
  buffer_load_dwordx4 v[220:223], v3, s[32:35], s62 offen offset:0 nt
  s_waitcnt vmcnt(5)
  buffer_load_dwordx4 v[224:227], v3, s[32:35], s62 offen offset:256 nt
  s_waitcnt vmcnt(5)
  buffer_load_dwordx4 v[228:231], v3, s[32:35], s62 offen offset:512 nt
  s_add_u32 s60, s60, 1
  s_and_b32 s60, s60, 63
  ds_read_b32 v31, v15 offset:480
  s_waitcnt lgkmcnt(4)
  v_and_b32 v56, v27, v8
  v_and_b32 v57, v27, v9
  v_and_b32 v58, v27, v10
  v_and_b32 v59, v27, v11
  s_nop 1
  v_mfma_f32_16x16x32_bf16 v[40:43], v[232:235], v[56:59], v[40:43]
  v_mfma_f32_16x16x32_bf16 v[44:47], v[236:239], v[56:59], v[44:47]
  v_mfma_f32_16x16x32_bf16 v[48:51], v[240:243], v[56:59], v[48:51]
  s_mul_i32 s62, s60, 12288
  s_add_u32 s62, s62, s61
  s_waitcnt vmcnt(5)
  buffer_load_dwordx4 v[232:235], v3, s[32:35], s62 offen offset:0 nt
  s_waitcnt vmcnt(5)
  buffer_load_dwordx4 v[236:239], v3, s[32:35], s62 offen offset:256 nt
  s_waitcnt vmcnt(5)
  buffer_load_dwordx4 v[240:243], v3, s[32:35], s62 offen offset:512 nt
  s_add_u32 s60, s60, 1
  s_and_b32 s60, s60, 63
  ds_read_b32 v24, v15 offset:512
  s_waitcnt lgkmcnt(4)
  v_and_b32 v52, v28, v8
  v_and_b32 v53, v28, v9
  v_and_b32 v54, v28, v10
  v_and_b32 v55, v28, v11
  s_nop 1
  v_mfma_f32_16x16x32_bf16 v[40:43], v[100:103], v[52:55], v[40:43]
  v_mfma_f32_16x16x32_bf16 v[44:47], v[104:107], v[52:55], v[44:47]
  v_mfma_f32_16x16x32_bf16 v[48:51], v[108:111], v[52:55], v[48:51]
  s_mul_i32 s62, s60, 12288
  s_add_u32 s62, s62, s61
  s_waitcnt vmcnt(5)
  buffer_load_dwordx4 v[100:103], v3, s[32:35], s62 offen offset:0 nt
  s_waitcnt vmcnt(5)
  buffer_load_dwordx4 v[104:107], v3, s[32:35], s62 offen offset:256 nt
  s_waitcnt vmcnt(5)
  buffer_load_dwordx4 v[108:111], v3, s[32:35], s62 offen offset:512 nt
  s_add_u32 s60, s60, 1
  s_and_b32 s60, s60, 63
  ds_read_b32 v25, v15 offset:544
  s_waitcnt lgkmcnt(4)
  v_and_b32 v56, v29, v8
  v_and_b32 v57, v29, v9
  v_and_b32 v58, v29, v10
  v_and_b32 v59, v29, v11
  s_nop 1
  v_mfma_f32_16x16x32_bf16 v[40:43], v[112:115], v[56:59], v[40:43]
  v_mfma_f32_16x16x32_bf16 v[44:47], v[116:119], v[56:59], v[44:47]
  v_mfma_f32_16x16x32_bf16 v[48:51], v[120:123], v[56:59], v[48:51]
  s_mul_i32 s62, s60, 12288
  s_add_u32 s62, s62, s61
  s_waitcnt vmcnt(5)
  buffer_load_dwordx4 v[112:115], v3, s[32:35], s62 offen offset:0 nt
  s_waitcnt vmcnt(5)
  buffer_load_dwordx4 v[116:119], v3, s[32:35], s62 offen offset:256 nt
  s_waitcnt vmcnt(5)
  buffer_load_dwordx4 v[120:123], v3, s[32:35], s62 offen offset:512 nt
  s_add_u32 s60, s60, 1
  s_and_b32 s60, s60, 63
  ds_read_b32 v26, v15 offset:576
  s_waitcnt lgkmcnt(4)
  v_and_b32 v52, v30, v8
  v_and_b32 v53, v30, v9
  v_and_b32 v54, v30, v10
  v_and_b32 v55, v30, v11
  s_nop 1
  v_mfma_f32_16x16x32_bf16 v[40:43], v[124:127], v[52:55], v[40:43]
  v_mfma_f32_16x16x32_bf16 v[44:47], v[128:131], v[52:55], v[44:47]
  v_mfma_f32_16x16x32_bf16 v[48:51], v[132:135], v[52:55], v[48:51]
  s_mul_i32 s62, s60, 12288
  s_add_u32 s62, s62, s61
  s_waitcnt vmcnt(5)
  buffer_load_dwordx4 v[124:127], v3, s[32:35], s62 offen offset:0 nt
  s_waitcnt vmcnt(5)
  buffer_load_dwordx4 v[128:131], v3, s[32:35], s62 offen offset:256 nt
  s_waitcnt vmcnt(5)
  buffer_load_dwordx4 v[132:135], v3, s[32:35], s62 offen offset:512 nt
  s_add_u32 s60, s60, 1
  s_and_b32 s60, s60, 63
  ds_read_b32 v27, v15 offset:608
  s_waitcnt lgkmcnt(4)
  v_and_b32 v56, v31, v8
  v_and_b32 v57, v31, v9
  v_and_b32 v58, v31, v10
  v_and_b32 v59, v31, v11
  s_nop 1
  v_mfma_f32_16x16x32_bf16 v[40:43], v[136:139], v[56:59], v[40:43]
  v_mfma_f32_16x16x32_bf16 v[44:47], v[140:143], v[56:59], v[44:47]
  v_mfma_f32_16x16x32_bf16 v[48:51], v[144:147], v[56:59], v[48:51]
  s_mul_i32 s62, s60, 12288
  s_add_u32 s62, s62, s61
  s_waitcnt vmcnt(5)
  buffer_load_dwordx4 v[136:139], v3, s[32:35], s62 offen offset:0 nt
  s_waitcnt vmcnt(5)
  buffer_load_dwordx4 v[140:143], v3, s[32:35], s62 offen offset:256 nt
  s_waitcnt vmcnt(5)
  buffer_load_dwordx4 v[144:147], v3, s[32:35], s62 offen offset:512 nt
  s_add_u32 s60, s60, 1
  s_and_b32 s60, s60, 63
  ds_read_b32 v28, v15 offset:640
  s_waitcnt lgkmcnt(4)
  v_and_b32 v52, v24, v8
  v_and_b32 v53, v24, v9
  v_and_b32 v54, v24, v10
  v_and_b32 v55, v24, v11
  s_nop 1
  v_mfma_f32_16x16x32_bf16 v[40:43], v[148:151], v[52:55], v[40:43]
  v_mfma_f32_16x16x32_bf16 v[44:47], v[152:155], v[52:55], v[44:47]
  v_mfma_f32_16x16x32_bf16 v[48:51], v[156:159], v[52:55], v[48:51]
  s_mul_i32 s62, s60, 12288
  s_add_u32 s62, s62, s61
  s_waitcnt vmcnt(5)
  buffer_load_dwordx4 v[148:151], v3, s[32:35], s62 offen offset:0 nt
  s_waitcnt vmcnt(5)
  buffer_load_dwordx4 v[152:155], v3, s[32:35], s62 offen offset:256 nt
  s_waitcnt vmcnt(5)
  buffer_load_dwordx4 v[156:159], v3, s[32:35], s62 offen offset:512 nt
  s_add_u32 s60, s60, 1
  s_and_b32 s60, s60, 63
  ds_read_b32 v29, v15 offset:672
  s_waitcnt lgkmcnt(4)
  v_and_b32 v56, v25, v8
  v_and_b32 v57, v25, v9
  v_and_b32 v58, v25, v10
  v_and_b32 v59, v25, v11
  s_nop 1
  v_mfma_f32_16x16x32_bf16 v[40:43], v[160:163], v[56:59], v[40:43]
  v_mfma_f32_16x16x32_bf16 v[44:47], v[164:167], v[56:59], v[44:47]
  v_mfma_f32_16x16x32_bf16 v[48:51], v[168:171], v[56:59], v[48:51]
  s_mul_i32 s62, s60, 12288
  s_add_u32 s62, s62, s61
  s_waitcnt vmcnt(5)
  buffer_load_dwordx4 v[160:163], v3, s[32:35], s62 offen offset:0 nt
  s_waitcnt vmcnt(5)
  buffer_load_dwordx4 v[164:167], v3, s[32:35], s62 offen offset:256 nt
  s_waitcnt vmcnt(5)
  buffer_load_dwordx4 v[168:171], v3, s[32:35], s62 offen offset:512 nt
  s_add_u32 s60, s60, 1
  s_and_b32 s60, s60, 63
  ds_read_b32 v30, v15 offset:704
  s_waitcnt lgkmcnt(4)
  v_and_b32 v52, v26, v8
  v_and_b32 v53, v26, v9
  v_and_b32 v54, v26, v10
  v_and_b32 v55, v26, v11
  s_nop 1
  v_mfma_f32_16x16x32_bf16 v[40:43], v[172:175], v[52:55], v[40:43]
  v_mfma_f32_16x16x32_bf16 v[44:47], v[176:179], v[52:55], v[44:47]
  v_mfma_f32_16x16x32_bf16 v[48:51], v[180:183], v[52:55], v[48:51]
  s_mul_i32 s62, s60, 12288
  s_add_u32 s62, s62, s61
  s_waitcnt vmcnt(5)
  buffer_load_dwordx4 v[172:175], v3, s[32:35], s62 offen offset:0 nt
  s_waitcnt vmcnt(5)
  buffer_load_dwordx4 v[176:179], v3, s[32:35], s62 offen offset:256 nt
  s_waitcnt vmcnt(5)
  buffer_load_dwordx4 v[180:183], v3, s[32:35], s62 offen offset:512 nt
  s_add_u32 s60, s60, 1
  s_and_b32 s60, s60, 63
  ds_read_b32 v31, v15 offset:736
  s_waitcnt lgkmcnt(4)
  v_and_b32 v56, v27, v8
  v_and_b32 v57, v27, v9
  v_and_b32 v58, v27, v10
  v_and_b32 v59, v27, v11
  s_nop 1
  v_mfma_f32_16x16x32_bf16 v[40:43], v[184:187], v[56:59], v[40:43]
  v_mfma_f32_16x16x32_bf16 v[44:47], v[188:191], v[56:59], v[44:47]
  v_mfma_f32_16x16x32_bf16 v[48:51], v[192:195], v[56:59], v[48:51]
  s_mul_i32 s62, s60, 12288
  s_add_u32 s62, s62, s61
  s_waitcnt vmcnt(5)
  buffer_load_dwordx4 v[184:187], v3, s[32:35], s62 offen offset:0 nt
  s_waitcnt vmcnt(5)
  buffer_load_dwordx4 v[188:191], v3, s[32:35], s62 offen offset:256 nt
  s_waitcnt vmcnt(5)
  buffer_load_dwordx4 v[192:195], v3, s[32:35], s62 offen offset:512 nt
  s_add_u32 s60, s60, 1
  s_and_b32 s60, s60, 63
  ds_read_b32 v24, v15 offset:768
  s_waitcnt lgkmcnt(4)
  v_and_b32 v52, v28, v8
  v_and_b32 v53, v28, v9
  v_and_b32 v54, v28, v10
  v_and_b32 v55, v28, v11
  s_nop 1
  v_mfma_f32_16x16x32_bf16 v[40:43], v[196:199], v[52:55], v[40:43]
  v_mfma_f32_16x16x32_bf16 v[44:47], v[200:203], v[52:55], v[44:47]
  v_mfma_f32_16x16x32_bf16 v[48:51], v[204:207], v[52:55], v[48:51]
  s_mul_i32 s62, s60, 12288
  s_add_u32 s62, s62, s61
  s_waitcnt vmcnt(5)
  buffer_load_dwordx4 v[196:199], v3, s[32:35], s62 offen offset:0 nt
  s_waitcnt vmcnt(5)
  buffer_load_dwordx4 v[200:203], v3, s[32:35], s62 offen offset:256 nt
  s_waitcnt vmcnt(5)
  buffer_load_dwordx4 v[204:207], v3, s[32:35], s62 offen offset:512 nt
  s_add_u32 s60, s60, 1
  s_and_b32 s60, s60, 63
  ds_read_b32 v25, v15 offset:800
  s_waitcnt lgkmcnt(4)
  v_and_b32 v56, v29, v8
  v_and_b32 v57, v29, v9
  v_and_b32 v58, v29, v10
  v_and_b32 v59, v29, v11
  s_nop 1
  v_mfma_f32_16x16x32_bf16 v[40:43], v[208:211], v[56:59], v[40:43]
  v_mfma_f32_16x16x32_bf16 v[44:47], v[212:215], v[56:59], v[44:47]
  v_mfma_f32_16x16x32_bf16 v[48:51], v[216:219], v[56:59], v[48:51]
  s_mul_i32 s62, s60, 12288
  s_add_u32 s62, s62, s61
  s_waitcnt vmcnt(5)
  buffer_load_dwordx4 v[208:211], v3, s[32:35], s62 offen offset:0 nt
  s_waitcnt vmcnt(5)
  buffer_load_dwordx4 v[212:215], v3, s[32:35], s62 offen offset:256 nt
  s_waitcnt vmcnt(5)
  buffer_load_dwordx4 v[216:219], v3, s[32:35], s62 offen offset:512 nt
  s_add_u32 s60, s60, 1
  s_and_b32 s60, s60, 63
  ds_read_b32 v26, v15 offset:832
  s_waitcnt lgkmcnt(4)
  v_and_b32 v52, v30, v8
  v_and_b32 v53, v30, v9
  v_and_b32 v54, v30, v10
  v_and_b32 v55, v30, v11
  s_nop 1
  v_mfma_f32_16x16x32_bf16 v[40:43], v[220:223], v[52:55], v[40:43]
  v_mfma_f32_16x16x32_bf16 v[44:47], v[224:227], v[52:55], v[44:47]
  v_mfma_f32_16x16x32_bf16 v[48:51], v[228:231], v[52:55], v[48:51]
  s_mul_i32 s62, s60, 12288
  s_add_u32 s62, s62, s61
  s_waitcnt vmcnt(5)
  buffer_load_dwordx4 v[220:223], v3, s[32:35], s62 offen offset:0 nt
  s_waitcnt vmcnt(5)
  buffer_load_dwordx4 v[224:227], v3, s[32:35], s62 offen offset:256 nt
  s_waitcnt vmcnt(5)
  buffer_load_dwordx4 v[228:231], v3, s[32:35], s62 offen offset:512 nt
  s_add_u32 s60, s60, 1
  s_and_b32 s60, s60, 63
  ds_read_b32 v27, v15 offset:864
  s_waitcnt lgkmcnt(4)
  v_and_b32 v56, v31, v8
  v_and_b32 v57, v31, v9
  v_and_b32 v58, v31, v10
  v_and_b32 v59, v31, v11
  s_nop 1
  v_mfma_f32_16x16x32_bf16 v[40:43], v[232:235], v[56:59], v[40:43]
  v_mfma_f32_16x16x32_bf16 v[44:47], v[236:239], v[56:59], v[44:47]
  v_mfma_f32_16x16x32_bf16 v[48:51], v[240:243], v[56:59], v[48:51]
  s_mul_i32 s62, s60, 12288
  s_add_u32 s62, s62, s61
  s_waitcnt vmcnt(5)
  buffer_load_dwordx4 v[232:235], v3, s[32:35], s62 offen offset:0 nt
  s_waitcnt vmcnt(5)
  buffer_load_dwordx4 v[236:239], v3, s[32:35], s62 offen offset:256 nt
  s_waitcnt vmcnt(5)
  buffer_load_dwordx4 v[240:243], v3, s[32:35], s62 offen offset:512 nt
  s_add_u32 s60, s60, 1
  s_and_b32 s60, s60, 63
  ds_read_b32 v28, v15 offset:896
  s_waitcnt lgkmcnt(4)
  v_and_b32 v52, v24, v8
  v_and_b32 v53, v24, v9
  v_and_b32 v54, v24, v10
  v_and_b32 v55, v24, v11
  s_nop 1
  v_mfma_f32_16x16x32_bf16 v[40:43], v[100:103], v[52:55], v[40:43]
  v_mfma_f32_16x16x32_bf16 v[44:47], v[104:107], v[52:55], v[44:47]
  v_mfma_f32_16x16x32_bf16 v[48:51], v[108:111], v[52:55], v[48:51]
  s_mul_i32 s62, s60, 12288
  s_add_u32 s62, s62, s61
  s_waitcnt vmcnt(5)
  buffer_load_dwordx4 v[100:103], v3, s[32:35], s62 offen offset:0 nt
  s_waitcnt vmcnt(5)
  buffer_load_dwordx4 v[104:107], v3, s[32:35], s62 offen offset:256 nt
  s_waitcnt vmcnt(5)
  buffer_load_dwordx4 v[108:111], v3, s[32:35], s62 offen offset:512 nt
  s_add_u32 s60, s60, 1
  s_and_b32 s60, s60, 63
  ds_read_b32 v29, v15 offset:928
  s_waitcnt lgkmcnt(4)
  v_and_b32 v56, v25, v8
  v_and_b32 v57, v25, v9
  v_and_b32 v58, v25, v10
  v_and_b32 v59, v25, v11
  s_nop 1
  v_mfma_f32_16x16x32_bf16 v[40:43], v[112:115], v[56:59], v[40:43]
  v_mfma_f32_16x16x32_bf16 v[44:47], v[116:119], v[56:59], v[44:47]
  v_mfma_f32_16x16x32_bf16 v[48:51], v[120:123], v[56:59], v[48:51]
  s_mul_i32 s62, s60, 12288
  s_add_u32 s62, s62, s61
  s_waitcnt vmcnt(5)
  buffer_load_dwordx4 v[112:115], v3, s[32:35], s62 offen offset:0 nt
  s_waitcnt vmcnt(5)
  buffer_load_dwordx4 v[116:119], v3, s[32:35], s62 offen offset:256 nt
  s_waitcnt vmcnt(5)
  buffer_load_dwordx4 v[120:123], v3, s[32:35], s62 offen offset:512 nt
  s_add_u32 s60, s60, 1
  s_and_b32 s60, s60, 63
  ds_read_b32 v30, v15 offset:960
  s_waitcnt lgkmcnt(4)
  v_and_b32 v52, v26, v8
  v_and_b32 v53, v26, v9
  v_and_b32 v54, v26, v10
  v_and_b32 v55, v26, v11
  s_nop 1
  v_mfma_f32_16x16x32_bf16 v[40:43], v[124:127], v[52:55], v[40:43]
  v_mfma_f32_16x16x32_bf16 v[44:47], v[128:131], v[52:55], v[44:47]
  v_mfma_f32_16x16x32_bf16 v[48:51], v[132:135], v[52:55], v[48:51]
  s_mul_i32 s62, s60, 12288
  s_add_u32 s62, s62, s61
  s_waitcnt vmcnt(5)
  buffer_load_dwordx4 v[124:127], v3, s[32:35], s62 offen offset:0 nt
  s_waitcnt vmcnt(5)
  buffer_load_dwordx4 v[128:131], v3, s[32:35], s62 offen offset:256 nt
  s_waitcnt vmcnt(5)
  buffer_load_dwordx4 v[132:135], v3, s[32:35], s62 offen offset:512 nt
  s_add_u32 s60, s60, 1
  s_and_b32 s60, s60, 63
  ds_read_b32 v31, v15 offset:992
  s_waitcnt lgkmcnt(4)
  v_and_b32 v56, v27, v8
  v_and_b32 v57, v27, v9
  v_and_b32 v58, v27, v10
  v_and_b32 v59, v27, v11
  s_nop 1
  v_mfma_f32_16x16x32_bf16 v[40:43], v[136:139], v[56:59], v[40:43]
  v_mfma_f32_16x16x32_bf16 v[44:47], v[140:143], v[56:59], v[44:47]
  v_mfma_f32_16x16x32_bf16 v[48:51], v[144:147], v[56:59], v[48:51]
  s_mul_i32 s62, s60, 12288
  s_add_u32 s62, s62, s61
  s_waitcnt vmcnt(5)
  buffer_load_dwordx4 v[136:139], v3, s[32:35], s62 offen offset:0 nt
  s_waitcnt vmcnt(5)
  buffer_load_dwordx4 v[140:143], v3, s[32:35], s62 offen offset:256 nt
  s_waitcnt vmcnt(5)
  buffer_load_dwordx4 v[144:147], v3, s[32:35], s62 offen offset:512 nt
  s_add_u32 s60, s60, 1
  s_and_b32 s60, s60, 63
  ds_read_b32 v24, v15 offset:1024
  s_waitcnt lgkmcnt(4)
  v_and_b32 v52, v28, v8
  v_and_b32 v53, v28, v9
  v_and_b32 v54, v28, v10
  v_and_b32 v55, v28, v11
  s_nop 1
  v_mfma_f32_16x16x32_bf16 v[40:43], v[148:151], v[52:55], v[40:43]
  v_mfma_f32_16x16x32_bf16 v[44:47], v[152:155], v[52:55], v[44:47]
  v_mfma_f32_16x16x32_bf16 v[48:51], v[156:159], v[52:55], v[48:51]
  s_mul_i32 s62, s60, 12288
  s_add_u32 s62, s62, s61
  s_waitcnt vmcnt(5)
  buffer_load_dwordx4 v[148:151], v3, s[32:35], s62 offen offset:0 nt
  s_waitcnt vmcnt(5)
  buffer_load_dwordx4 v[152:155], v3, s[32:35], s62 offen offset:256 nt
  s_waitcnt vmcnt(5)
  buffer_load_dwordx4 v[156:159], v3, s[32:35], s62 offen offset:512 nt
  s_add_u32 s60, s60, 1
  s_and_b32 s60, s60, 63
  s_mov_b32 exec_lo, 0x000001ff
  s_mov_b32 exec_hi, 0x00000000
  s_waitcnt vmcnt(5)
  buffer_load_dwordx4 v[60:63], v18, s[44:47], 0 offen sc1 nt
  s_mov_b64 exec, -1
  ds_read_b32 v25, v15 offset:1056
  s_waitcnt lgkmcnt(4)
  v_and_b32 v56, v29, v8
  v_and_b32 v57, v29, v9
  v_and_b32 v58, v29, v10
  v_and_b32 v59, v29, v11
  s_nop 1
  v_mfma_f32_16x16x32_bf16 v[40:43], v[160:163], v[56:59], v[40:43]
  v_mfma_f32_16x16x32_bf16 v[44:47], v[164:167], v[56:59], v[44:47]
  v_mfma_f32_16x16x32_bf16 v[48:51], v[168:171], v[56:59], v[48:51]
  s_mul_i32 s62, s60, 12288
  s_add_u32 s62, s62, s61
  s_waitcnt vmcnt(5)
  buffer_load_dwordx4 v[160:163], v3, s[32:35], s62 offen offset:0 nt
  s_waitcnt vmcnt(5)
  buffer_load_dwordx4 v[164:167], v3, s[32:35], s62 offen offset:256 nt
  s_waitcnt vmcnt(5)
  buffer_load_dwordx4 v[168:171], v3, s[32:35], s62 offen offset:512 nt
  s_add_u32 s60, s60, 1
  s_and_b32 s60, s60, 63
  ds_read_b32 v26, v15 offset:1088
  s_waitcnt lgkmcnt(4)
  v_and_b32 v52, v30, v8
  v_and_b32 v53, v30, v9
  v_and_b32 v54, v30, v10
  v_and_b32 v55, v30, v11
  s_nop 1
  v_mfma_f32_16x16x32_bf16 v[40:43], v[172:175], v[52:55], v[40:43]
  v_mfma_f32_16x16x32_bf16 v[44:47], v[176:179], v[52:55], v[44:47]
  v_mfma_f32_16x16x32_bf16 v[48:51], v[180:183], v[52:55], v[48:51]
  s_mul_i32 s62, s60, 12288
  s_add_u32 s62, s62, s61
  s_waitcnt vmcnt(5)
  buffer_load_dwordx4 v[172:175], v3, s[32:35], s62 offen offset:0 nt
  s_waitcnt vmcnt(5)
  buffer_load_dwordx4 v[176:179], v3, s[32:35], s62 offen offset:256 nt
  s_waitcnt vmcnt(5)
  buffer_load_dwordx4 v[180:183], v3, s[32:35], s62 offen offset:512 nt
  s_add_u32 s60, s60, 1
  s_and_b32 s60, s60, 63
  ds_read_b32 v27, v15 offset:1120
  s_waitcnt lgkmcnt(4)
  v_and_b32 v56, v31, v8
  v_and_b32 v57, v31, v9
  v_and_b32 v58, v31, v10
  v_and_b32 v59, v31, v11
  s_nop 1
  v_mfma_f32_16x16x32_bf16 v[40:43], v[184:187], v[56:59], v[40:43]
  v_mfma_f32_16x16x32_bf16 v[44:47], v[188:191], v[56:59], v[44:47]
  v_mfma_f32_16x16x32_bf16 v[48:51], v[192:195], v[56:59], v[48:51]
  s_mul_i32 s62, s60, 12288
  s_add_u32 s62, s62, s61
  s_waitcnt vmcnt(5)
  buffer_load_dwordx4 v[184:187], v3, s[32:35], s62 offen offset:0 nt
  s_waitcnt vmcnt(5)
  buffer_load_dwordx4 v[188:191], v3, s[32:35], s62 offen offset:256 nt
  s_waitcnt vmcnt(5)
  buffer_load_dwordx4 v[192:195], v3, s[32:35], s62 offen offset:512 nt
  s_add_u32 s60, s60, 1
  s_and_b32 s60, s60, 63
  ds_read_b32 v28, v15 offset:1152
  s_waitcnt lgkmcnt(4)
  v_and_b32 v52, v24, v8
  v_and_b32 v53, v24, v9
  v_and_b32 v54, v24, v10
  v_and_b32 v55, v24, v11
  s_nop 1
  v_mfma_f32_16x16x32_bf16 v[40:43], v[196:199], v[52:55], v[40:43]
  v_mfma_f32_16x16x32_bf16 v[44:47], v[200:203], v[52:55], v[44:47]
  v_mfma_f32_16x16x32_bf16 v[48:51], v[204:207], v[52:55], v[48:51]
  s_mul_i32 s62, s60, 12288
  s_add_u32 s62, s62, s61
  s_waitcnt vmcnt(5)
  buffer_load_dwordx4 v[196:199], v3, s[32:35], s62 offen offset:0 nt
  s_waitcnt vmcnt(5)
  buffer_load_dwordx4 v[200:203], v3, s[32:35], s62 offen offset:256 nt
  s_waitcnt vmcnt(5)
  buffer_load_dwordx4 v[204:207], v3, s[32:35], s62 offen offset:512 nt
  s_add_u32 s60, s60, 1
  s_and_b32 s60, s60, 63
  ds_read_b32 v29, v15 offset:1184
  s_waitcnt lgkmcnt(4)
  v_and_b32 v56, v25, v8
  v_and_b32 v57, v25, v9
  v_and_b32 v58, v25, v10
  v_and_b32 v59, v25, v11
  s_nop 1
  v_mfma_f32_16x16x32_bf16 v[40:43], v[208:211], v[56:59], v[40:43]
  v_mfma_f32_16x16x32_bf16 v[44:47], v[212:215], v[56:59], v[44:47]
  v_mfma_f32_16x16x32_bf16 v[48:51], v[216:219], v[56:59], v[48:51]
  s_mul_i32 s62, s60, 12288
  s_add_u32 s62, s62, s61
  s_waitcnt vmcnt(5)
  buffer_load_dwordx4 v[208:211], v3, s[32:35], s62 offen offset:0 nt
  s_waitcnt vmcnt(5)
  buffer_load_dwordx4 v[212:215], v3, s[32:35], s62 offen offset:256 nt
  s_waitcnt vmcnt(5)
  buffer_load_dwordx4 v[216:219], v3, s[32:35], s62 offen offset:512 nt
  s_add_u32 s60, s60, 1
  s_and_b32 s60, s60, 63
  ds_read_b32 v30, v15 offset:1216
  s_waitcnt lgkmcnt(4)
  v_and_b32 v52, v26, v8
  v_and_b32 v53, v26, v9
  v_and_b32 v54, v26, v10
  v_and_b32 v55, v26, v11
  s_nop 1
  v_mfma_f32_16x16x32_bf16 v[40:43], v[220:223], v[52:55], v[40:43]
  v_mfma_f32_16x16x32_bf16 v[44:47], v[224:227], v[52:55], v[44:47]
  v_mfma_f32_16x16x32_bf16 v[48:51], v[228:231], v[52:55], v[48:51]
  s_mul_i32 s62, s60, 12288
  s_add_u32 s62, s62, s61
  s_waitcnt vmcnt(5)
  buffer_load_dwordx4 v[220:223], v3, s[32:35], s62 offen offset:0 nt
  s_waitcnt vmcnt(5)
  buffer_load_dwordx4 v[224:227], v3, s[32:35], s62 offen offset:256 nt
  s_waitcnt vmcnt(5)
  buffer_load_dwordx4 v[228:231], v3, s[32:35], s62 offen offset:512 nt
  s_add_u32 s60, s60, 1
  s_and_b32 s60, s60, 63
  ds_read_b32 v31, v15 offset:1248
  s_waitcnt lgkmcnt(4)
  v_and_b32 v56, v27, v8
  v_and_b32 v57, v27, v9
  v_and_b32 v58, v27, v10
  v_and_b32 v59, v27, v11
  s_nop 1
  v_mfma_f32_16x16x32_bf16 v[40:43], v[232:235], v[56:59], v[40:43]
  v_mfma_f32_16x16x32_bf16 v[44:47], v[236:239], v[56:59], v[44:47]
  v_mfma_f32_16x16x32_bf16 v[48:51], v[240:243], v[56:59], v[48:51]
  s_mul_i32 s62, s60, 12288
  s_add_u32 s62, s62, s61
  s_waitcnt vmcnt(5)
  buffer_load_dwordx4 v[232:235], v3, s[32:35], s62 offen offset:0 nt
  s_waitcnt vmcnt(5)
  buffer_load_dwordx4 v[236:239], v3, s[32:35], s62 offen offset:256 nt
  s_waitcnt vmcnt(5)
  buffer_load_dwordx4 v[240:243], v3, s[32:35], s62 offen offset:512 nt
  s_add_u32 s60, s60, 1
  s_and_b32 s60, s60, 63
  ds_read_b32 v24, v15 offset:1280
  s_waitcnt lgkmcnt(4)
  v_and_b32 v52, v28, v8
  v_and_b32 v53, v28, v9
  v_and_b32 v54, v28, v10
  v_and_b32 v55, v28, v11
  s_nop 1
  v_mfma_f32_16x16x32_bf16 v[40:43], v[100:103], v[52:55], v[40:43]
  v_mfma_f32_16x16x32_bf16 v[44:47], v[104:107], v[52:55], v[44:47]
  v_mfma_f32_16x16x32_bf16 v[48:51], v[108:111], v[52:55], v[48:51]
  s_mul_i32 s62, s60, 12288
  s_add_u32 s62, s62, s61
  s_waitcnt vmcnt(5)
  buffer_load_dwordx4 v[100:103], v3, s[32:35], s62 offen offset:0 nt
  s_waitcnt vmcnt(5)
  buffer_load_dwordx4 v[104:107], v3, s[32:35], s62 offen offset:256 nt
  s_waitcnt vmcnt(5)
  buffer_load_dwordx4 v[108:111], v3, s[32:35], s62 offen offset:512 nt
  s_add_u32 s60, s60, 1
  s_and_b32 s60, s60, 63
  s_mov_b32 s68, 1048576
L_mlchk:
  v_cmp_ne_u32 vcc, s48, v62
  s_nop 1
  s_and_b32 vcc_lo, vcc_lo, 0x1ff
  s_cbranch_scc0 L_mlok
  s_sub_u32 s68, s68, 1
  s_cmp_eq_u32 s68, 0
  s_cbranch_scc1 L_mlok
  s_sleep 8
  s_mov_b32 exec_lo, 0x000001ff
  s_mov_b32 exec_hi, 0x00000000
  buffer_load_dwordx4 v[60:63], v18, s[44:47], 0 offen sc1 nt
  s_mov_b64 exec, -1
  s_waitcnt vmcnt(0)
  s_branch L_mlchk
L_mlok:
  v_mov_b32 v19, v60
  s_nop 1
  v_max_f32_dpp v19, v19, v19 quad_perm:[1,0,3,2] row_mask:0xf bank_mask:0xf
  s_nop 1
  v_max_f32_dpp v19, v19, v19 quad_perm:[2,3,0,1] row_mask:0xf bank_mask:0xf
  s_nop 1
  v_max_f32_dpp v19, v19, v19 row_half_mirror row_mask:0xf bank_mask:0xf
  v_sub_f32 v20, v60, v19
  v_sub_f32 v19, s65, v19
  v_mul_f32 v20, 0x3fb8aa3b, v20
  v_mul_f32 v19, 0x3fb8aa3b, v19
  v_exp_f32 v20, v20
  v_exp_f32 v19, v19
  v_mul_f32 v20, v20, v61
  s_nop 1
  v_add_f32_dpp v20, v20, v20 quad_perm:[1,0,3,2] row_mask:0xf bank_mask:0xf
  s_nop 1
  v_add_f32_dpp v20, v20, v20 quad_perm:[2,3,0,1] row_mask:0xf bank_mask:0xf
  s_nop 1
  v_add_f32_dpp v20, v20, v20 row_half_mirror row_mask:0xf bank_mask:0xf
  v_rcp_f32 v20, v20
  s_nop 0
  v_mul_f32 v20, v20, v19
  s_nop 0
  v_readfirstlane_b32 s67, v20
  s_mov_b32 s8, s67
  s_mov_b32 s9, s67
  s_mov_b32 s10, 0x00ff00ff
  s_mov_b32 s11, 0x00ff00ff
  s_mov_b32 s12, 0x00ff00ff
  s_mov_b32 s13, 0xff00ff00
  s_mov_b32 s14, 0xff00ff00
  s_mov_b32 s15, 0xff00ff00
  s_lshr_b32 s57, s52, 1
  s_mul_i32 s57, s57, 24
  s_and_b32 s58, s52, 1
  s_lshl_b32 s58, s58, 2
  s_add_u32 s57, s57, s58
  v_bfe_u32 v19, v1, 4, 1
  v_and_b32 v20, 1, v1
  v_lshl_add_u32 v19, v19, 1, v20
  v_add_lshl_u32 v19, v19, s57, 4
  v_and_b32 v20, 14, v1
  v_min_u32 v20, 10, v20
  v_lshrrev_b32 v21, 5, v1
  v_add_u32 v20, v20, v21
  v_lshrrev_b32 v21, 2, v20
  v_lshl_add_u32 v19, v21, 7, v19
  v_and_b32 v20, 3, v20
  v_lshl_add_u32 v4, v20, 2, v19
  v_and_b32 v19, 4, v1
  v_cmp_eq_u32 vcc, 0, v19
  v_mov_b32 v20, -1
  v_and_b32 v21, 3, v1
  v_cndmask_b32 v84, 0, v20, vcc
  v_not_b32 v85, v84
  v_mul_u32_u24 v86, 0x5555, v21
  v_mov_b32 v64, 0
  v_mov_b32 v65, 0
  v_mov_b32 v66, 0
  v_mov_b32 v67, 0
  v_mov_b32 v68, 0
  v_mov_b32 v69, 0
  v_mov_b32 v70, 0
  v_mov_b32 v71, 0
  v_mov_b32 v72, 0
  v_mov_b32 v73, 0
  v_mov_b32 v74, 0
  v_mov_b32 v75, 0
  v_mov_b32 v76, 0
  v_mov_b32 v77, 0
  v_mov_b32 v78, 0
  v_mov_b32 v79, 0
  v_mov_b32 v80, 0
  v_mov_b32 v81, 0
  v_mov_b32 v82, 0
  v_mov_b32 v83, 0
  v_and_b32 v19, 15, v1
  v_bfe_u32 v20, v1, 4, 1
  v_lshl_add_u32 v19, v19, 1, v20
  s_mul_i32 s57, s52, 2560
  v_lshl_add_u32 v14, v19, 4, s57
  s_lshl_b32 s16, s53, 7
  s_add_u32 s16, s16, 12288
  v_mov_b32 v18, 1
  v_lshrrev_b32 v19, 4, v0
  v_mul_u32_u24 v19, 15, v19
  v_and_b32 v20, 15, v0
  v_add_u32 v19, v19, v20
  v_cmp_eq_u32 vcc, 15, v20
  v_mov_b32 v17, 1.0
  v_mov_b32 v88, -1
  v_cndmask_b32 v17, 0, v17, vcc
  v_cndmask_b32 v88, v88, 0, vcc
  v_cmp_gt_u32 vcc, 160, v19
  v_add_u32 v21, 0, v19
  v_min_u32 v21, 639, v21
  v_lshlrev_b32 v5, 2, v21
  v_add_u32 v21, 240, v19
  v_min_u32 v21, 639, v21
  v_lshlrev_b32 v6, 2, v21
  v_add_u32 v21, 480, v19
  v_min_u32 v21, 639, v21
  v_lshlrev_b32 v16, 2, v21
  v_cndmask_b32 v89, 0, v88, vcc
  s_mul_i32 s63, s53, 3072
  ds_read_b32 v25, v15 offset:1312
  s_waitcnt lgkmcnt(4)
  v_and_b32 v56, v29, v8
  v_and_b32 v57, v29, v9
  v_and_b32 v58, v29, v10
  v_and_b32 v59, v29, v11
  s_nop 1
  v_mfma_f32_16x16x32_bf16 v[40:43], v[112:115], v[56:59], v[40:43]
  v_mfma_f32_16x16x32_bf16 v[44:47], v[116:119], v[56:59], v[44:47]
  v_mfma_f32_16x16x32_bf16 v[48:51], v[120:123], v[56:59], v[48:51]
  s_mul_i32 s62, s60, 12288
  s_add_u32 s62, s62, s61
  s_waitcnt vmcnt(5)
  buffer_load_dwordx4 v[112:115], v3, s[32:35], s62 offen offset:0 nt
  s_waitcnt vmcnt(5)
  buffer_load_dwordx4 v[116:119], v3, s[32:35], s62 offen offset:256 nt
  s_waitcnt vmcnt(5)
  buffer_load_dwordx4 v[120:123], v3, s[32:35], s62 offen offset:512 nt
  s_add_u32 s60, s60, 1
  s_and_b32 s60, s60, 63
  ds_read_b32 v26, v15 offset:1344
  s_waitcnt lgkmcnt(4)
  v_and_b32 v52, v30, v8
  v_and_b32 v53, v30, v9
  v_and_b32 v54, v30, v10
  v_and_b32 v55, v30, v11
  s_nop 1
  v_mfma_f32_16x16x32_bf16 v[40:43], v[124:127], v[52:55], v[40:43]
  v_mfma_f32_16x16x32_bf16 v[44:47], v[128:131], v[52:55], v[44:47]
  v_mfma_f32_16x16x32_bf16 v[48:51], v[132:135], v[52:55], v[48:51]
  s_mul_i32 s62, s60, 12288
  s_add_u32 s62, s62, s61
  s_waitcnt vmcnt(5)
  buffer_load_dwordx4 v[124:127], v3, s[32:35], s62 offen offset:0 nt
  s_waitcnt vmcnt(5)
  buffer_load_dwordx4 v[128:131], v3, s[32:35], s62 offen offset:256 nt
  s_waitcnt vmcnt(5)
  buffer_load_dwordx4 v[132:135], v3, s[32:35], s62 offen offset:512 nt
  s_add_u32 s60, s60, 1
  s_and_b32 s60, s60, 63
  ds_read_b32 v27, v15 offset:1376
  s_waitcnt lgkmcnt(4)
  v_and_b32 v56, v31, v8
  v_and_b32 v57, v31, v9
  v_and_b32 v58, v31, v10
  v_and_b32 v59, v31, v11
  s_nop 1
  v_mfma_f32_16x16x32_bf16 v[40:43], v[136:139], v[56:59], v[40:43]
  v_mfma_f32_16x16x32_bf16 v[44:47], v[140:143], v[56:59], v[44:47]
  v_mfma_f32_16x16x32_bf16 v[48:51], v[144:147], v[56:59], v[48:51]
  s_mul_i32 s62, s60, 12288
  s_add_u32 s62, s62, s61
  s_waitcnt vmcnt(5)
  buffer_load_dwordx4 v[136:139], v3, s[32:35], s62 offen offset:0 nt
  s_waitcnt vmcnt(5)
  buffer_load_dwordx4 v[140:143], v3, s[32:35], s62 offen offset:256 nt
  s_waitcnt vmcnt(5)
  buffer_load_dwordx4 v[144:147], v3, s[32:35], s62 offen offset:512 nt
  s_add_u32 s60, s60, 1
  s_and_b32 s60, s60, 63
  ds_read_b32 v28, v15 offset:1408
  s_waitcnt lgkmcnt(4)
  v_and_b32 v52, v24, v8
  v_and_b32 v53, v24, v9
  v_and_b32 v54, v24, v10
  v_and_b32 v55, v24, v11
  s_nop 1
  v_mfma_f32_16x16x32_bf16 v[40:43], v[148:151], v[52:55], v[40:43]
  v_mfma_f32_16x16x32_bf16 v[44:47], v[152:155], v[52:55], v[44:47]
  v_mfma_f32_16x16x32_bf16 v[48:51], v[156:159], v[52:55], v[48:51]
  s_mul_i32 s62, s60, 12288
  s_add_u32 s62, s62, s61
  s_waitcnt vmcnt(5)
  buffer_load_dwordx4 v[148:151], v3, s[32:35], s62 offen offset:0 nt
  s_waitcnt vmcnt(5)
  buffer_load_dwordx4 v[152:155], v3, s[32:35], s62 offen offset:256 nt
  s_waitcnt vmcnt(5)
  buffer_load_dwordx4 v[156:159], v3, s[32:35], s62 offen offset:512 nt
  s_add_u32 s60, s60, 1
  s_and_b32 s60, s60, 63
  ds_read_b32 v29, v15 offset:1440
  s_waitcnt lgkmcnt(4)
  v_and_b32 v56, v25, v8
  v_and_b32 v57, v25, v9
  v_and_b32 v58, v25, v10
  v_and_b32 v59, v25, v11
  s_nop 1
  v_mfma_f32_16x16x32_bf16 v[40:43], v[160:163], v[56:59], v[40:43]
  v_mfma_f32_16x16x32_bf16 v[44:47], v[164:167], v[56:59], v[44:47]
  v_mfma_f32_16x16x32_bf16 v[48:51], v[168:171], v[56:59], v[48:51]
  s_mul_i32 s62, s60, 12288
  s_add_u32 s62, s62, s61
  s_waitcnt vmcnt(5)
  buffer_load_dwordx4 v[160:163], v3, s[32:35], s62 offen offset:0 nt
  s_waitcnt vmcnt(5)
  buffer_load_dwordx4 v[164:167], v3, s[32:35], s62 offen offset:256 nt
  s_waitcnt vmcnt(5)
  buffer_load_dwordx4 v[168:171], v3, s[32:35], s62 offen offset:512 nt
  s_add_u32 s60, s60, 1
  s_and_b32 s60, s60, 63
  ds_read_b32 v30, v15 offset:1472
  s_waitcnt lgkmcnt(4)
  v_and_b32 v52, v26, v8
  v_and_b32 v53, v26, v9
  v_and_b32 v54, v26, v10
  v_and_b32 v55, v26, v11
  s_nop 1
  v_mfma_f32_16x16x32_bf16 v[40:43], v[172:175], v[52:55], v[40:43]
  v_mfma_f32_16x16x32_bf16 v[44:47], v[176:179], v[52:55], v[44:47]
  v_mfma_f32_16x16x32_bf16 v[48:51], v[180:183], v[52:55], v[48:51]
  s_mul_i32 s62, s60, 12288
  s_add_u32 s62, s62, s61
  s_waitcnt vmcnt(5)
  buffer_load_dwordx4 v[172:175], v3, s[32:35], s62 offen offset:0 nt
  s_waitcnt vmcnt(5)
  buffer_load_dwordx4 v[176:179], v3, s[32:35], s62 offen offset:256 nt
  s_waitcnt vmcnt(5)
  buffer_load_dwordx4 v[180:183], v3, s[32:35], s62 offen offset:512 nt
  s_add_u32 s60, s60, 1
  s_and_b32 s60, s60, 63
  ds_read_b32 v31, v15 offset:1504
  s_waitcnt lgkmcnt(4)
  v_and_b32 v56, v27, v8
  v_and_b32 v57, v27, v9
  v_and_b32 v58, v27, v10
  v_and_b32 v59, v27, v11
  s_nop 1
  v_mfma_f32_16x16x32_bf16 v[40:43], v[184:187], v[56:59], v[40:43]
  v_mfma_f32_16x16x32_bf16 v[44:47], v[188:191], v[56:59], v[44:47]
  v_mfma_f32_16x16x32_bf16 v[48:51], v[192:195], v[56:59], v[48:51]
  s_mul_i32 s62, s60, 12288
  s_add_u32 s62, s62, s61
  s_waitcnt vmcnt(5)
  buffer_load_dwordx4 v[184:187], v3, s[32:35], s62 offen offset:0 nt
  s_waitcnt vmcnt(5)
  buffer_load_dwordx4 v[188:191], v3, s[32:35], s62 offen offset:256 nt
  s_waitcnt vmcnt(5)
  buffer_load_dwordx4 v[192:195], v3, s[32:35], s62 offen offset:512 nt
  s_add_u32 s60, s60, 1
  s_and_b32 s60, s60, 63
  ds_read_b32 v24, v15 offset:1536
  s_waitcnt lgkmcnt(4)
  v_and_b32 v52, v28, v8
  v_and_b32 v53, v28, v9
  v_and_b32 v54, v28, v10
  v_and_b32 v55, v28, v11
  s_nop 1
  v_mfma_f32_16x16x32_bf16 v[40:43], v[196:199], v[52:55], v[40:43]
  v_mfma_f32_16x16x32_bf16 v[44:47], v[200:203], v[52:55], v[44:47]
  v_mfma_f32_16x16x32_bf16 v[48:51], v[204:207], v[52:55], v[48:51]
  s_mul_i32 s62, s60, 12288
  s_add_u32 s62, s62, s61
  s_waitcnt vmcnt(5)
  buffer_load_dwordx4 v[196:199], v3, s[32:35], s62 offen offset:0 nt
  s_waitcnt vmcnt(5)
  buffer_load_dwordx4 v[200:203], v3, s[32:35], s62 offen offset:256 nt
  s_waitcnt vmcnt(5)
  buffer_load_dwordx4 v[204:207], v3, s[32:35], s62 offen offset:512 nt
  s_add_u32 s60, s60, 1
  s_and_b32 s60, s60, 63
  ds_read_b32 v25, v15 offset:1568
  s_waitcnt lgkmcnt(4)
  v_and_b32 v56, v29, v8
  v_and_b32 v57, v29, v9
  v_and_b32 v58, v29, v10
  v_and_b32 v59, v29, v11
  s_nop 1
  v_mfma_f32_16x16x32_bf16 v[40:43], v[208:211], v[56:59], v[40:43]
  v_mfma_f32_16x16x32_bf16 v[44:47], v[212:215], v[56:59], v[44:47]
  v_mfma_f32_16x16x32_bf16 v[48:51], v[216:219], v[56:59], v[48:51]
  s_mul_i32 s62, s60, 12288
  s_add_u32 s62, s62, s61
  s_waitcnt vmcnt(5)
  buffer_load_dwordx4 v[208:211], v3, s[32:35], s62 offen offset:0 nt
  s_waitcnt vmcnt(5)
  buffer_load_dwordx4 v[212:215], v3, s[32:35], s62 offen offset:256 nt
  s_waitcnt vmcnt(5)
  buffer_load_dwordx4 v[216:219], v3, s[32:35], s62 offen offset:512 nt
  s_add_u32 s60, s60, 1
  s_and_b32 s60, s60, 63
  ds_read_b32 v26, v15 offset:1600
  s_waitcnt lgkmcnt(4)
  v_and_b32 v52, v30, v8
  v_and_b32 v53, v30, v9
  v_and_b32 v54, v30, v10
  v_and_b32 v55, v30, v11
  s_nop 1
  v_mfma_f32_16x16x32_bf16 v[40:43], v[220:223], v[52:55], v[40:43]
  v_mfma_f32_16x16x32_bf16 v[44:47], v[224:227], v[52:55], v[44:47]
  v_mfma_f32_16x16x32_bf16 v[48:51], v[228:231], v[52:55], v[48:51]
  s_mul_i32 s62, s60, 12288
  s_add_u32 s62, s62, s61
  s_waitcnt vmcnt(5)
  buffer_load_dwordx4 v[220:223], v3, s[32:35], s62 offen offset:0 nt
  s_waitcnt vmcnt(5)
  buffer_load_dwordx4 v[224:227], v3, s[32:35], s62 offen offset:256 nt
  s_waitcnt vmcnt(5)
  buffer_load_dwordx4 v[228:231], v3, s[32:35], s62 offen offset:512 nt
  s_add_u32 s60, s60, 1
  s_and_b32 s60, s60, 63
  ds_read_b32 v27, v15 offset:1632
  s_waitcnt lgkmcnt(4)
  v_and_b32 v56, v31, v8
  v_and_b32 v57, v31, v9
  v_and_b32 v58, v31, v10
  v_and_b32 v59, v31, v11
  s_nop 1
  v_mfma_f32_16x16x32_bf16 v[40:43], v[232:235], v[56:59], v[40:43]
  v_mfma_f32_16x16x32_bf16 v[44:47], v[236:239], v[56:59], v[44:47]
  v_mfma_f32_16x16x32_bf16 v[48:51], v[240:243], v[56:59], v[48:51]
  s_mul_i32 s62, s60, 12288
  s_add_u32 s62, s62, s61
  s_waitcnt vmcnt(5)
  buffer_load_dwordx4 v[232:235], v3, s[32:35], s62 offen offset:0 nt
  s_waitcnt vmcnt(5)
  buffer_load_dwordx4 v[236:239], v3, s[32:35], s62 offen offset:256 nt
  s_waitcnt vmcnt(5)
  buffer_load_dwordx4 v[240:243], v3, s[32:35], s62 offen offset:512 nt
  s_add_u32 s60, s60, 1
  s_and_b32 s60, s60, 63
  ds_read_b32 v28, v15 offset:1664
  s_waitcnt lgkmcnt(4)
  v_and_b32 v52, v24, v8
  v_and_b32 v53, v24, v9
  v_and_b32 v54, v24, v10
  v_and_b32 v55, v24, v11
  s_nop 1
  v_mfma_f32_16x16x32_bf16 v[40:43], v[100:103], v[52:55], v[40:43]
  v_mfma_f32_16x16x32_bf16 v[44:47], v[104:107], v[52:55], v[44:47]
  v_mfma_f32_16x16x32_bf16 v[48:51], v[108:111], v[52:55], v[48:51]
  s_mul_i32 s62, s60, 12288
  s_add_u32 s62, s62, s61
  buffer_load_dwordx4 v[100:103], v3, s[32:35], s62 offen offset:0 nt
  buffer_load_dwordx4 v[104:107], v3, s[32:35], s62 offen offset:256 nt
  buffer_load_dwordx4 v[108:111], v3, s[32:35], s62 offen offset:512 nt
  s_add_u32 s60, s60, 1
  s_and_b32 s60, s60, 63
  ds_read_b32 v29, v15 offset:1696
  s_waitcnt lgkmcnt(4)
  v_and_b32 v56, v25, v8
  v_and_b32 v57, v25, v9
  v_and_b32 v58, v25, v10
  v_and_b32 v59, v25, v11
  s_nop 1
  v_mfma_f32_16x16x32_bf16 v[40:43], v[112:115], v[56:59], v[40:43]
  v_mfma_f32_16x16x32_bf16 v[44:47], v[116:119], v[56:59], v[44:47]
  v_mfma_f32_16x16x32_bf16 v[48:51], v[120:123], v[56:59], v[48:51]
  s_mul_i32 s62, s60, 12288
  s_add_u32 s62, s62, s61
  buffer_load_dwordx4 v[112:115], v3, s[32:35], s62 offen offset:0 nt
  buffer_load_dwordx4 v[116:119], v3, s[32:35], s62 offen offset:256 nt
  buffer_load_dwordx4 v[120:123], v3, s[32:35], s62 offen offset:512 nt
  s_add_u32 s60, s60, 1
  s_and_b32 s60, s60, 63
  ds_read_b32 v30, v15 offset:1728
  s_waitcnt lgkmcnt(4)
  v_and_b32 v52, v26, v8
  v_and_b32 v53, v26, v9
  v_and_b32 v54, v26, v10
  v_and_b32 v55, v26, v11
  s_nop 1
  v_mfma_f32_16x16x32_bf16 v[40:43], v[124:127], v[52:55], v[40:43]
  v_mfma_f32_16x16x32_bf16 v[44:47], v[128:131], v[52:55], v[44:47]
  v_mfma_f32_16x16x32_bf16 v[48:51], v[132:135], v[52:55], v[48:51]
  s_mul_i32 s62, s60, 12288
  s_add_u32 s62, s62, s61
  buffer_load_dwordx4 v[124:127], v3, s[32:35], s62 offen offset:0 nt
  buffer_load_dwordx4 v[128:131], v3, s[32:35], s62 offen offset:256 nt
  buffer_load_dwordx4 v[132:135], v3, s[32:35], s62 offen offset:512 nt
  s_add_u32 s60, s60, 1
  s_and_b32 s60, s60, 63
  ds_read_b32 v31, v15 offset:1760
  s_waitcnt lgkmcnt(4)
  v_and_b32 v56, v27, v8
  v_and_b32 v57, v27, v9
  v_and_b32 v58, v27, v10
  v_and_b32 v59, v27, v11
  s_nop 1
  v_mfma_f32_16x16x32_bf16 v[40:43], v[136:139], v[56:59], v[40:43]
  v_mfma_f32_16x16x32_bf16 v[44:47], v[140:143], v[56:59], v[44:47]
  v_mfma_f32_16x16x32_bf16 v[48:51], v[144:147], v[56:59], v[48:51]
  s_mul_i32 s62, s60, 12288
  s_add_u32 s62, s62, s61
  buffer_load_dwordx4 v[136:139], v3, s[32:35], s62 offen offset:0 nt
  buffer_load_dwordx4 v[140:143], v3, s[32:35], s62 offen offset:256 nt
  buffer_load_dwordx4 v[144:147], v3, s[32:35], s62 offen offset:512 nt
  s_add_u32 s60, s60, 1
  s_and_b32 s60, s60, 63
  ds_read_b32 v24, v15 offset:1792
  s_waitcnt lgkmcnt(4)
  v_and_b32 v52, v28, v8
  v_and_b32 v53, v28, v9
  v_and_b32 v54, v28, v10
  v_and_b32 v55, v28, v11
  s_nop 1
  v_mfma_f32_16x16x32_bf16 v[40:43], v[148:151], v[52:55], v[40:43]
  v_mfma_f32_16x16x32_bf16 v[44:47], v[152:155], v[52:55], v[44:47]
  v_mfma_f32_16x16x32_bf16 v[48:51], v[156:159], v[52:55], v[48:51]
  ds_read_b32 v25, v15 offset:1824
  s_waitcnt lgkmcnt(4)
  v_and_b32 v56, v29, v8
  v_and_b32 v57, v29, v9
  v_and_b32 v58, v29, v10
  v_and_b32 v59, v29, v11
  s_nop 1
  v_mfma_f32_16x16x32_bf16 v[40:43], v[160:163], v[56:59], v[40:43]
  v_mfma_f32_16x16x32_bf16 v[44:47], v[164:167], v[56:59], v[44:47]
  v_mfma_f32_16x16x32_bf16 v[48:51], v[168:171], v[56:59], v[48:51]
  ds_read_b32 v26, v15 offset:1856
  s_waitcnt lgkmcnt(4)
  v_and_b32 v52, v30, v8
  v_and_b32 v53, v30, v9
  v_and_b32 v54, v30, v10
  v_and_b32 v55, v30, v11
  s_nop 1
  v_mfma_f32_16x16x32_bf16 v[40:43], v[172:175], v[52:55], v[40:43]
  v_mfma_f32_16x16x32_bf16 v[44:47], v[176:179], v[52:55], v[44:47]
  v_mfma_f32_16x16x32_bf16 v[48:51], v[180:183], v[52:55], v[48:51]
  ds_read_b32 v27, v15 offset:1888
  s_waitcnt lgkmcnt(4)
  v_and_b32 v56, v31, v8
  v_and_b32 v57, v31, v9
  v_and_b32 v58, v31, v10
  v_and_b32 v59, v31, v11
  s_nop 1
  v_mfma_f32_16x16x32_bf16 v[40:43], v[184:187], v[56:59], v[40:43]
  v_mfma_f32_16x16x32_bf16 v[44:47], v[188:191], v[56:59], v[44:47]
  v_mfma_f32_16x16x32_bf16 v[48:51], v[192:195], v[56:59], v[48:51]
  ds_read_b32 v28, v15 offset:1920
  s_waitcnt lgkmcnt(4)
  v_and_b32 v52, v24, v8
  v_and_b32 v53, v24, v9
  v_and_b32 v54, v24, v10
  v_and_b32 v55, v24, v11
  s_nop 1
  v_mfma_f32_16x16x32_bf16 v[40:43], v[196:199], v[52:55], v[40:43]
  v_mfma_f32_16x16x32_bf16 v[44:47], v[200:203], v[52:55], v[44:47]
  v_mfma_f32_16x16x32_bf16 v[48:51], v[204:207], v[52:55], v[48:51]
  ds_read_b32 v29, v15 offset:1952
  s_waitcnt lgkmcnt(4)
  v_and_b32 v56, v25, v8
  v_and_b32 v57, v25, v9
  v_and_b32 v58, v25, v10
  v_and_b32 v59, v25, v11
  s_nop 1
  v_mfma_f32_16x16x32_bf16 v[40:43], v[208:211], v[56:59], v[40:43]
  v_mfma_f32_16x16x32_bf16 v[44:47], v[212:215], v[56:59], v[44:47]
  v_mfma_f32_16x16x32_bf16 v[48:51], v[216:219], v[56:59], v[48:51]
  ds_read_b32 v30, v15 offset:1984
  s_waitcnt lgkmcnt(4)
  v_and_b32 v52, v26, v8
  v_and_b32 v53, v26, v9
  v_and_b32 v54, v26, v10
  v_and_b32 v55, v26, v11
  s_waitcnt vmcnt(15)
  s_nop 1
  v_mfma_f32_16x16x32_bf16 v[40:43], v[220:223], v[52:55], v[40:43]
  v_mfma_f32_16x16x32_bf16 v[44:47], v[224:227], v[52:55], v[44:47]
  v_mfma_f32_16x16x32_bf16 v[48:51], v[228:231], v[52:55], v[48:51]
  ds_read_b32 v31, v15 offset:2016
  s_waitcnt lgkmcnt(4)
  v_and_b32 v56, v27, v8
  v_and_b32 v57, v27, v9
  v_and_b32 v58, v27, v10
  v_and_b32 v59, v27, v11
  s_waitcnt vmcnt(12)
  s_nop 1
  v_mfma_f32_16x16x32_bf16 v[40:43], v[232:235], v[56:59], v[40:43]
  v_mfma_f32_16x16x32_bf16 v[44:47], v[236:239], v[56:59], v[44:47]
  v_mfma_f32_16x16x32_bf16 v[48:51], v[240:243], v[56:59], v[48:51]
  s_waitcnt lgkmcnt(3)
  v_and_b32 v52, v28, v8
  v_and_b32 v53, v28, v9
  v_and_b32 v54, v28, v10
  v_and_b32 v55, v28, v11
  s_waitcnt vmcnt(9)
  s_nop 1
  v_mfma_f32_16x16x32_bf16 v[40:43], v[100:103], v[52:55], v[40:43]
  v_mfma_f32_16x16x32_bf16 v[44:47], v[104:107], v[52:55], v[44:47]
  v_mfma_f32_16x16x32_bf16 v[48:51], v[108:111], v[52:55], v[48:51]
  s_waitcnt lgkmcnt(2)
  v_and_b32 v56, v29, v8
  v_and_b32 v57, v29, v9
  v_and_b32 v58, v29, v10
  v_and_b32 v59, v29, v11
  s_waitcnt vmcnt(6)
  s_nop 1
  v_mfma_f32_16x16x32_bf16 v[40:43], v[112:115], v[56:59], v[40:43]
  v_mfma_f32_16x16x32_bf16 v[44:47], v[116:119], v[56:59], v[44:47]
  v_mfma_f32_16x16x32_bf16 v[48:51], v[120:123], v[56:59], v[48:51]
  s_waitcnt lgkmcnt(1)
  v_and_b32 v52, v30, v8
  v_and_b32 v53, v30, v9
  v_and_b32 v54, v30, v10
  v_and_b32 v55, v30, v11
  s_waitcnt vmcnt(3)
  s_nop 1
  v_mfma_f32_16x16x32_bf16 v[40:43], v[124:127], v[52:55], v[40:43]
  v_mfma_f32_16x16x32_bf16 v[44:47], v[128:131], v[52:55], v[44:47]
  v_mfma_f32_16x16x32_bf16 v[48:51], v[132:135], v[52:55], v[48:51]
  s_waitcnt lgkmcnt(0)
  v_and_b32 v56, v31, v8
  v_and_b32 v57, v31, v9
  v_and_b32 v58, v31, v10
  v_and_b32 v59, v31, v11
  s_waitcnt vmcnt(0)
  s_nop 1
  v_mfma_f32_16x16x32_bf16 v[40:43], v[136:139], v[56:59], v[40:43]
  v_mfma_f32_16x16x32_bf16 v[44:47], v[140:143], v[56:59], v[44:47]
  v_mfma_f32_16x16x32_bf16 v[48:51], v[144:147], v[56:59], v[48:51]
  s_nop 5
  s_mov_b64 exec, s[10:11]
  v_pk_mul_f32 v[40:41], v[40:41], s[8:9]
  v_pk_mul_f32 v[42:43], v[42:43], s[8:9]
  ds_write_b128 v12, v[40:43] offset:10240
  s_mov_b64 exec, s[12:13]
  v_pk_mul_f32 v[44:45], v[44:45], s[8:9]
  v_pk_mul_f32 v[46:47], v[46:47], s[8:9]
  ds_write_b128 v12, v[44:47] offset:10752
  s_mov_b64 exec, s[14:15]
  v_pk_mul_f32 v[48:49], v[48:49], s[8:9]
  v_pk_mul_f32 v[50:51], v[50:51], s[8:9]
  ds_write_b128 v12, v[48:51] offset:11264
  s_mov_b64 exec, 1
  s_cmp_lg_u32 s52, 3
  s_cbranch_scc1 L_notick
  buffer_atomic_add v18, v23, s[44:47], s16 offen sc0
L_notick:
  s_mov_b64 exec, -1
  s_waitcnt lgkmcnt(0)
  s_barrier
  ds_read2st64_b32 v[52:53], v4 offset0:40 offset1:43
  ds_read2st64_b32 v[54:55], v4 offset0:46 offset1:49
  ds_read2st64_b32 v[56:57], v4 offset0:52 offset1:55
  ds_read2st64_b32 v[58:59], v4 offset0:58 offset1:61
  s_waitcnt lgkmcnt(2)
  v_pk_add_f32 v[52:53], v[52:53], v[54:55]
  s_waitcnt lgkmcnt(0)
  v_pk_add_f32 v[56:57], v[56:57], v[58:59]
  v_pk_add_f32 v[52:53], v[52:53], v[56:57]
  v_add_f32 v52, v52, v53
  v_cvt_pk_bf16_f32 v53, 0, v52
  v_sub_f32 v53, v52, v53
  v_cvt_pk_bf16_f32 v54, v52, v53
  s_nop 1
  v_and_b32_dpp v100, v54, v84 row_newbcast:0 row_mask:0xf bank_mask:0xf
  v_and_b32_dpp v101, v54, v85 row_newbcast:0 row_mask:0xf bank_mask:0xf
  v_and_b32_dpp v102, v54, v84 row_newbcast:1 row_mask:0xf bank_mask:0xf
  v_and_b32_dpp v103, v54, v85 row_newbcast:1 row_mask:0xf bank_mask:0xf
  v_and_b32_dpp v104, v54, v84 row_newbcast:2 row_mask:0xf bank_mask:0xf
  v_and_b32_dpp v105, v54, v85 row_newbcast:2 row_mask:0xf bank_mask:0xf
  v_smfmac_f32_16x16x64_bf16 v[64:67], v[100:103], a[0:7], v86
  v_and_b32_dpp v106, v54, v84 row_newbcast:3 row_mask:0xf bank_mask:0xf
  v_smfmac_f32_16x16x64_bf16 v[68:71], v[100:103], a[8:15], v86
  v_and_b32_dpp v107, v54, v85 row_newbcast:3 row_mask:0xf bank_mask:0xf
  v_smfmac_f32_16x16x64_bf16 v[72:75], v[100:103], a[16:23], v86
  v_and_b32_dpp v108, v54, v84 row_newbcast:4 row_mask:0xf bank_mask:0xf
  v_smfmac_f32_16x16x64_bf16 v[76:79], v[100:103], a[24:31], v86
  v_and_b32_dpp v109, v54, v85 row_newbcast:4 row_mask:0xf bank_mask:0xf
  v_smfmac_f32_16x16x64_bf16 v[80:83], v[100:103], a[32:39], v86
  v_and_b32_dpp v110, v54, v84 row_newbcast:5 row_mask:0xf bank_mask:0xf
  v_smfmac_f32_16x16x64_bf16 v[64:67], v[104:107], a[40:47], v86
  v_and_b32_dpp v111, v54, v85 row_newbcast:5 row_mask:0xf bank_mask:0xf
  v_smfmac_f32_16x16x64_bf16 v[68:71], v[104:107], a[48:55], v86
  v_and_b32_dpp v112, v54, v84 row_newbcast:6 row_mask:0xf bank_mask:0xf
  v_smfmac_f32_16x16x64_bf16 v[72:75], v[104:107], a[56:63], v86
  v_and_b32_dpp v113, v54, v85 row_newbcast:6 row_mask:0xf bank_mask:0xf
  v_smfmac_f32_16x16x64_bf16 v[76:79], v[104:107], a[64:71], v86
  v_and_b32_dpp v114, v54, v84 row_newbcast:7 row_mask:0xf bank_mask:0xf
  v_smfmac_f32_16x16x64_bf16 v[80:83], v[104:107], a[72:79], v86
  v_and_b32_dpp v115, v54, v85 row_newbcast:7 row_mask:0xf bank_mask:0xf
  v_smfmac_f32_16x16x64_bf16 v[64:67], v[108:111], a[80:87], v86
  v_and_b32_dpp v116, v54, v84 row_newbcast:8 row_mask:0xf bank_mask:0xf
  v_smfmac_f32_16x16x64_bf16 v[68:71], v[108:111], a[88:95], v86
  v_and_b32_dpp v117, v54, v85 row_newbcast:8 row_mask:0xf bank_mask:0xf
  v_smfmac_f32_16x16x64_bf16 v[72:75], v[108:111], a[96:103], v86
  v_and_b32_dpp v118, v54, v84 row_newbcast:9 row_mask:0xf bank_mask:0xf
  v_smfmac_f32_16x16x64_bf16 v[76:79], v[108:111], a[104:111], v86
  v_and_b32_dpp v119, v54, v85 row_newbcast:9 row_mask:0xf bank_mask:0xf
  v_smfmac_f32_16x16x64_bf16 v[80:83], v[108:111], a[112:119], v86
  v_and_b32_dpp v120, v54, v84 row_newbcast:10 row_mask:0xf bank_mask:0xf
  v_smfmac_f32_16x16x64_bf16 v[64:67], v[112:115], a[120:127], v86
  v_and_b32_dpp v121, v54, v85 row_newbcast:10 row_mask:0xf bank_mask:0xf
  v_smfmac_f32_16x16x64_bf16 v[68:71], v[112:115], a[128:135], v86
  v_and_b32_dpp v122, v54, v84 row_newbcast:11 row_mask:0xf bank_mask:0xf
  v_smfmac_f32_16x16x64_bf16 v[72:75], v[112:115], a[136:143], v86
  v_and_b32_dpp v123, v54, v85 row_newbcast:11 row_mask:0xf bank_mask:0xf
  v_smfmac_f32_16x16x64_bf16 v[76:79], v[112:115], a[144:151], v86
  v_smfmac_f32_16x16x64_bf16 v[80:83], v[112:115], a[152:159], v86
  v_smfmac_f32_16x16x64_bf16 v[64:67], v[116:119], a[160:167], v86
  v_smfmac_f32_16x16x64_bf16 v[64:67], v[120:123], a[200:207], v86
  v_smfmac_f32_16x16x64_bf16 v[68:71], v[116:119], a[168:175], v86
  v_smfmac_f32_16x16x64_bf16 v[68:71], v[120:123], a[208:215], v86
  v_smfmac_f32_16x16x64_bf16 v[72:75], v[116:119], a[176:183], v86
  v_smfmac_f32_16x16x64_bf16 v[72:75], v[120:123], a[216:223], v86
  v_smfmac_f32_16x16x64_bf16 v[76:79], v[116:119], a[184:191], v86
  v_smfmac_f32_16x16x64_bf16 v[76:79], v[120:123], a[224:231], v86
  v_smfmac_f32_16x16x64_bf16 v[80:83], v[116:119], a[192:199], v86
  v_smfmac_f32_16x16x64_bf16 v[80:83], v[120:123], a[232:239], v86
  s_mov_b32 exec_hi, 0
  ds_write_b128 v14, v[64:67] offset:37248
  s_nop 0
  ds_write_b128 v14, v[68:71] offset:37760
  s_nop 0
  ds_write_b128 v14, v[72:75] offset:38272
  s_nop 0
  ds_write_b128 v14, v[76:79] offset:38784
  s_nop 0
  ds_write_b128 v14, v[80:83] offset:39296
  s_mov_b64 exec, -1
  s_waitcnt lgkmcnt(0)
  s_barrier
  ds_read_b32 v40, v5 offset:37248
  ds_read_b32 v41, v5 offset:39808
  ds_read_b32 v42, v5 offset:42368
  ds_read_b32 v43, v5 offset:44928
  ds_read_b32 v44, v6 offset:37248
  ds_read_b32 v45, v6 offset:39808
  ds_read_b32 v46, v6 offset:42368
  ds_read_b32 v47, v6 offset:44928
  s_cmp_eq_u32 s52, 3
  s_cbranch_scc1 L_two
  ds_read_b32 v48, v16 offset:37248
  ds_read_b32 v49, v16 offset:39808
  ds_read_b32 v50, v16 offset:42368
  ds_read_b32 v51, v16 offset:44928
  s_waitcnt lgkmcnt(0)
  v_add_f32 v48, v48, v49
  v_add_f32 v50, v50, v51
  v_add_f32 v48, v48, v50
  v_and_or_b32 v48, v48, v89, v17
  buffer_atomic_add_f32 v48, v13, s[44:47], s63 offen offset:2048
L_two:
  s_waitcnt lgkmcnt(0)
  v_add_f32 v40, v40, v41
  v_add_f32 v42, v42, v43
  v_add_f32 v44, v44, v45
  v_add_f32 v46, v46, v47
  v_add_f32 v40, v40, v42
  v_add_f32 v44, v44, v46
  v_and_or_b32 v40, v40, v88, v17
  buffer_atomic_add_f32 v40, v13, s[44:47], s63 offen offset:0
  v_and_or_b32 v44, v44, v88, v17
  buffer_atomic_add_f32 v44, v13, s[44:47], s63 offen offset:1024
  s_cmp_lg_u32 s52, 3
  s_cbranch_scc1 L_done
  s_waitcnt vmcnt(2)
  v_readfirstlane_b32 s57, v18
  s_cmp_lg_u32 s57, 0
  s_cbranch_scc1 L_done
  s_load_dwordx2 s[8:9], s[0:1], 0
  s_mul_i32 s57, s53, 1280
  s_add_u32 s36, s20, s57
  s_addc_u32 s37, s21, 0
  s_mov_b32 s38, 1280
  s_mov_b32 s39, 0x20000
  v_lshrrev_b32 v19, 4, v1
  v_mul_u32_u24 v19, 15, v19
  v_and_b32 v21, 15, v1
  v_add_lshl_u32 v19, v19, v21, 1
  v_cmp_eq_u32 vcc, 15, v21
  v_mov_b32 v21, 0x10000
  v_mov_b32 v89, 0
  v_cndmask_b32 v19, v19, v21, vcc
  s_mov_b32 exec_lo, 0x7fff7fff
  s_mov_b32 exec_hi, 0x000003ff
  v_mov_b32 v89, -1
  s_mov_b64 exec, -1
  v_mov_b32 v4, v89
  v_mov_b32 v136, 0
  v_mov_b32 v137, 0
  v_mov_b32 v138, 0
  v_mov_b32 v139, 0
  v_mov_b32 v140, 0
  v_mov_b32 v141, 0
  v_mov_b32 v142, 0
  v_mov_b32 v143, 0
  v_mov_b32 v144, 0
  v_mov_b32 v145, 0
  v_mov_b32 v146, 0
  v_mov_b32 v147, 0
  s_waitcnt lgkmcnt(0)
  s_add_u32 s24, s8, s57
  s_addc_u32 s25, s9, 0
  s_mov_b32 s26, 1280
  s_mov_b32 s27, 0x20000
  buffer_load_short_d16_hi v136, v19, s[24:27], 0 offen offset:0
  buffer_load_short_d16_hi v137, v19, s[24:27], 0 offen offset:120
  buffer_load_short_d16_hi v138, v19, s[24:27], 0 offen offset:240
  buffer_load_short_d16_hi v139, v19, s[24:27], 0 offen offset:360
  buffer_load_short_d16_hi v140, v19, s[24:27], 0 offen offset:480
  buffer_load_short_d16_hi v141, v19, s[24:27], 0 offen offset:600
  buffer_load_short_d16_hi v142, v19, s[24:27], 0 offen offset:720
  buffer_load_short_d16_hi v143, v19, s[24:27], 0 offen offset:840
  buffer_load_short_d16_hi v144, v19, s[24:27], 0 offen offset:960
  buffer_load_short_d16_hi v145, v19, s[24:27], 0 offen offset:1080
  buffer_load_short_d16_hi v146, v19, s[24:27], 0 offen offset:1200
  v_lshlrev_b32 v20, 4, v1
  v_lshlrev_b32 v21, 3, v1
  s_mov_b32 s68, 1048576
L_tabld:
  s_mov_b32 s57, 65536
  buffer_load_dwordx4 a[0:3], v20, s[44:47], s57 offen offset:0 sc1 nt
  buffer_load_dwordx4 a[4:7], v20, s[44:47], s57 offen offset:1024 sc1 nt
  buffer_load_dwordx4 a[8:11], v20, s[44:47], s57 offen offset:2048 sc1 nt
  buffer_load_dwordx4 a[12:15], v20, s[44:47], s57 offen offset:3072 sc1 nt
  s_mov_b32 s57, 69632
  buffer_load_dwordx4 a[16:19], v20, s[44:47], s57 offen offset:0 sc1 nt
  buffer_load_dwordx4 a[20:23], v20, s[44:47], s57 offen offset:1024 sc1 nt
  buffer_load_dwordx4 a[24:27], v20, s[44:47], s57 offen offset:2048 sc1 nt
  buffer_load_dwordx4 a[28:31], v20, s[44:47], s57 offen offset:3072 sc1 nt
  s_mov_b32 s57, 73728
  buffer_load_dwordx4 a[32:35], v20, s[44:47], s57 offen offset:0 sc1 nt
  buffer_load_dwordx4 a[36:39], v20, s[44:47], s57 offen offset:1024 sc1 nt
  buffer_load_dwordx4 a[40:43], v20, s[44:47], s57 offen offset:2048 sc1 nt
  buffer_load_dwordx4 a[44:47], v20, s[44:47], s57 offen offset:3072 sc1 nt
  s_mov_b32 s57, 77824
  buffer_load_dwordx4 a[48:51], v20, s[44:47], s57 offen offset:0 sc1 nt
  buffer_load_dwordx4 a[52:55], v20, s[44:47], s57 offen offset:1024 sc1 nt
  buffer_load_dwordx4 a[56:59], v20, s[44:47], s57 offen offset:2048 sc1 nt
  buffer_load_dwordx4 a[60:63], v20, s[44:47], s57 offen offset:3072 sc1 nt
  s_mov_b32 s57, 81920
  buffer_load_dwordx4 a[64:67], v20, s[44:47], s57 offen offset:0 sc1 nt
  buffer_load_dwordx4 a[68:71], v20, s[44:47], s57 offen offset:1024 sc1 nt
  buffer_load_dwordx4 a[72:75], v20, s[44:47], s57 offen offset:2048 sc1 nt
  buffer_load_dwordx4 a[76:79], v20, s[44:47], s57 offen offset:3072 sc1 nt
  s_mov_b32 s57, 86016
  buffer_load_dwordx4 a[80:83], v20, s[44:47], s57 offen offset:0 sc1 nt
  buffer_load_dwordx4 a[84:87], v20, s[44:47], s57 offen offset:1024 sc1 nt
  buffer_load_dwordx4 a[88:91], v20, s[44:47], s57 offen offset:2048 sc1 nt
  buffer_load_dwordx4 a[92:95], v20, s[44:47], s57 offen offset:3072 sc1 nt
  s_mov_b32 s57, 90112
  buffer_load_dwordx4 a[96:99], v20, s[44:47], s57 offen offset:0 sc1 nt
  buffer_load_dwordx4 a[100:103], v20, s[44:47], s57 offen offset:1024 sc1 nt
  buffer_load_dwordx4 a[104:107], v20, s[44:47], s57 offen offset:2048 sc1 nt
  buffer_load_dwordx4 a[108:111], v20, s[44:47], s57 offen offset:3072 sc1 nt
  s_mov_b32 s57, 94208
  buffer_load_dwordx4 a[112:115], v20, s[44:47], s57 offen offset:0 sc1 nt
  buffer_load_dwordx4 a[116:119], v20, s[44:47], s57 offen offset:1024 sc1 nt
  buffer_load_dwordx4 a[120:123], v20, s[44:47], s57 offen offset:2048 sc1 nt
  buffer_load_dwordx4 a[124:127], v20, s[44:47], s57 offen offset:3072 sc1 nt
  v_mov_b32 v22, 0
  v_add_u32 v18, 0x10000, v21
  s_waitcnt vmcnt(24) lgkmcnt(0)
  v_accvgpr_read_b32 v172, a2
  ds_write_b64 v21, a[0:1] offset:47488
  v_xor_b32 v172, s48, v172
  v_accvgpr_read_b32 v173, a6
  ds_write_b64 v21, a[4:5] offset:48000
  v_xor_b32 v173, s48, v173
  v_or3_b32 v22, v172, v173, v22
  v_accvgpr_read_b32 v172, a10
  ds_write_b64 v21, a[8:9] offset:48512
  v_xor_b32 v172, s48, v172
  v_accvgpr_read_b32 v173, a14
  ds_write_b64 v21, a[12:13] offset:49024
  v_xor_b32 v173, s48, v173
  v_or3_b32 v22, v172, v173, v22
  v_accvgpr_read_b32 v172, a18
  ds_write_b64 v21, a[16:17] offset:49536
  v_xor_b32 v172, s48, v172
  v_accvgpr_read_b32 v173, a22
  ds_write_b64 v21, a[20:21] offset:50048
  v_xor_b32 v173, s48, v173
  v_or3_b32 v22, v172, v173, v22
  v_accvgpr_read_b32 v172, a26
  ds_write_b64 v21, a[24:25] offset:50560
  v_xor_b32 v172, s48, v172
  v_accvgpr_read_b32 v173, a30
  ds_write_b64 v21, a[28:29] offset:51072
  v_xor_b32 v173, s48, v173
  v_or3_b32 v22, v172, v173, v22
  s_waitcnt vmcnt(16) lgkmcnt(0)
  v_accvgpr_read_b32 v172, a34
  ds_write_b64 v21, a[32:33] offset:51584
  v_xor_b32 v172, s48, v172
  v_accvgpr_read_b32 v173, a38
  ds_write_b64 v21, a[36:37] offset:52096
  v_xor_b32 v173, s48, v173
  v_or3_b32 v22, v172, v173, v22
  v_accvgpr_read_b32 v172, a42
  ds_write_b64 v21, a[40:41] offset:52608
  v_xor_b32 v172, s48, v172
  v_accvgpr_read_b32 v173, a46
  ds_write_b64 v21, a[44:45] offset:53120
  v_xor_b32 v173, s48, v173
  v_or3_b32 v22, v172, v173, v22
  v_accvgpr_read_b32 v172, a50
  ds_write_b64 v21, a[48:49] offset:53632
  v_xor_b32 v172, s48, v172
  v_accvgpr_read_b32 v173, a54
  ds_write_b64 v21, a[52:53] offset:54144
  v_xor_b32 v173, s48, v173
  v_or3_b32 v22, v172, v173, v22
  v_accvgpr_read_b32 v172, a58
  ds_write_b64 v21, a[56:57] offset:54656
  v_xor_b32 v172, s48, v172
  v_accvgpr_read_b32 v173, a62
  ds_write_b64 v21, a[60:61] offset:55168
  v_xor_b32 v173, s48, v173
  v_or3_b32 v22, v172, v173, v22
  s_waitcnt vmcnt(8) lgkmcnt(0)
  v_accvgpr_read_b32 v172, a66
  ds_write_b64 v18, a[64:65] offset:47488
  v_xor_b32 v172, s48, v172
  v_accvgpr_read_b32 v173, a70
  ds_write_b64 v18, a[68:69] offset:48000
  v_xor_b32 v173, s48, v173
  v_or3_b32 v22, v172, v173, v22
  v_accvgpr_read_b32 v172, a74
  ds_write_b64 v18, a[72:73] offset:48512
  v_xor_b32 v172, s48, v172
  v_accvgpr_read_b32 v173, a78
  ds_write_b64 v18, a[76:77] offset:49024
  v_xor_b32 v173, s48, v173
  v_or3_b32 v22, v172, v173, v22
  v_accvgpr_read_b32 v172, a82
  ds_write_b64 v18, a[80:81] offset:49536
  v_xor_b32 v172, s48, v172
  v_accvgpr_read_b32 v173, a86
  ds_write_b64 v18, a[84:85] offset:50048
  v_xor_b32 v173, s48, v173
  v_or3_b32 v22, v172, v173, v22
  v_accvgpr_read_b32 v172, a90
  ds_write_b64 v18, a[88:89] offset:50560
  v_xor_b32 v172, s48, v172
  v_accvgpr_read_b32 v173, a94
  ds_write_b64 v18, a[92:93] offset:51072
  v_xor_b32 v173, s48, v173
  v_or3_b32 v22, v172, v173, v22
  s_waitcnt vmcnt(0) lgkmcnt(0)
  v_accvgpr_read_b32 v172, a98
  ds_write_b64 v18, a[96:97] offset:51584
  v_xor_b32 v172, s48, v172
  v_accvgpr_read_b32 v173, a102
  ds_write_b64 v18, a[100:101] offset:52096
  v_xor_b32 v173, s48, v173
  v_or3_b32 v22, v172, v173, v22
  v_accvgpr_read_b32 v172, a106
  ds_write_b64 v18, a[104:105] offset:52608
  v_xor_b32 v172, s48, v172
  v_accvgpr_read_b32 v173, a110
  ds_write_b64 v18, a[108:109] offset:53120
  v_xor_b32 v173, s48, v173
  v_or3_b32 v22, v172, v173, v22
  v_accvgpr_read_b32 v172, a114
  ds_write_b64 v18, a[112:113] offset:53632
  v_xor_b32 v172, s48, v172
  v_accvgpr_read_b32 v173, a118
  ds_write_b64 v18, a[116:117] offset:54144
  v_xor_b32 v173, s48, v173
  v_or3_b32 v22, v172, v173, v22
  v_accvgpr_read_b32 v172, a122
  ds_write_b64 v18, a[120:121] offset:54656
  v_xor_b32 v172, s48, v172
  v_accvgpr_read_b32 v173, a126
  ds_write_b64 v18, a[124:125] offset:55168
  v_xor_b32 v173, s48, v173
  v_or3_b32 v22, v172, v173, v22
  v_cmp_ne_u32 vcc, 0, v22
  s_sub_u32 s68, s68, 1
  s_waitcnt lgkmcnt(0)
  s_cmp_eq_u32 s68, 0
  s_cbranch_scc1 L_tabok
  s_cbranch_vccz L_tabok
  s_sleep 8
  s_branch L_tabld
L_tabok:
  v_mov_b32 v18, s48
  s_mov_b32 s58, 45056
  s_mov_b64 exec, 1
  buffer_store_dword v18, v23, s[44:47], s58 offen sc1
  s_mov_b64 exec, -1
  s_mov_b32 s38, 0
  s_mov_b32 s51, 1
  s_branch L_pollok
L_start:
  s_mov_b64 exec, -1
  s_mov_b32 s38, 1280
  s_mov_b32 s51, 0
  v_mov_b32 v124, 0
  v_mov_b32 v125, 0
  v_mov_b32 v126, 0
  v_mov_b32 v127, 0
  v_mov_b32 v128, 0
  v_mov_b32 v129, 0
  v_mov_b32 v130, 0
  v_mov_b32 v131, 0
  v_mov_b32 v132, 0
  v_mov_b32 v133, 0
  v_mov_b32 v134, 0
  v_mov_b32 v135, 0
  v_mov_b32 v160, 0
  v_mov_b32 v161, 0
  v_mov_b32 v162, 0
  v_mov_b32 v163, 0
  v_mov_b32 v164, 0
  v_mov_b32 v165, 0
  v_mov_b32 v166, 0
  v_mov_b32 v167, 0
  v_mov_b32 v168, 0
  v_mov_b32 v169, 0
  v_mov_b32 v170, 0
  v_mov_b32 v171, 0
  v_mov_b32 v111, 0
  v_lshlrev_b32 v20, 2, v1
  s_mov_b32 s68, 1048576
  s_mov_b32 s4, 0x80008000
L_poll:
  buffer_load_dword v100, v20, s[44:47], s63 offen offset:0 sc1
  buffer_load_dword v101, v20, s[44:47], s63 offen offset:256 sc1
  buffer_load_dword v102, v20, s[44:47], s63 offen offset:512 sc1
  buffer_load_dword v103, v20, s[44:47], s63 offen offset:768 sc1
  buffer_load_dword v104, v20, s[44:47], s63 offen offset:1024 sc1
  buffer_load_dword v105, v20, s[44:47], s63 offen offset:1280 sc1
  buffer_load_dword v106, v20, s[44:47], s63 offen offset:1536 sc1
  buffer_load_dword v107, v20, s[44:47], s63 offen offset:1792 sc1
  buffer_load_dword v108, v20, s[44:47], s63 offen offset:2048 sc1
  buffer_load_dword v109, v20, s[44:47], s63 offen offset:2304 sc1
  buffer_load_dword v110, v20, s[44:47], s63 offen offset:2560 sc1
  s_sub_u32 s68, s68, 1
  s_waitcnt vmcnt(0) lgkmcnt(0)
  v_min3_f32 v21, v100, v101, v102
  v_min3_f32 v22, v103, v104, v105
  v_min3_f32 v21, v106, v107, v21
  v_min3_f32 v22, v108, v109, v22
  v_min3_f32 v21, v110, v21, v22
  s_cmp_eq_u32 s68, 0
  s_cbranch_scc1 L_pollok
  v_cmp_neq_f32 vcc, 0x42800000, v21
  v_cvt_pk_bf16_f32 v100, 0, v100
  v_cvt_pk_bf16_f32 v101, 0, v101
  s_or_b32 vcc_lo, vcc_lo, vcc_hi
  s_and_b32 vcc_lo, vcc_lo, s4
  s_cbranch_scc1 L_poll
L_pollok:
  s_mov_b32 exec_lo, 0x7fff7fff
  s_mov_b32 exec_hi, 0x7fff7fff
  v_cvt_pk_bf16_f32 v102, 0, v102
  v_cvt_pk_bf16_f32 v103, 0, v103
  v_cvt_pk_bf16_f32 v104, 0, v104
  v_cvt_pk_bf16_f32 v105, 0, v105
  v_cvt_pk_bf16_f32 v106, 0, v106
  v_cvt_pk_bf16_f32 v107, 0, v107
  v_cvt_pk_bf16_f32 v108, 0, v108
  v_cvt_pk_bf16_f32 v109, 0, v109
  v_cvt_pk_bf16_f32 v110, 0, v110
  v_pk_add_f32 v[100:101], v[100:101], v[136:137]
  v_pk_add_f32 v[102:103], v[102:103], v[138:139]
  v_pk_add_f32 v[104:105], v[104:105], v[140:141]
  v_pk_add_f32 v[106:107], v[106:107], v[142:143]
  v_pk_add_f32 v[108:109], v[108:109], v[144:145]
  v_pk_add_f32 v[110:111], v[110:111], v[146:147]
  v_cvt_pk_bf16_f32 v100, 0, v100
  v_cvt_pk_bf16_f32 v101, 0, v101
  v_cvt_pk_bf16_f32 v102, 0, v102
  v_cvt_pk_bf16_f32 v103, 0, v103
  v_cvt_pk_bf16_f32 v104, 0, v104
  v_cvt_pk_bf16_f32 v105, 0, v105
  v_cvt_pk_bf16_f32 v106, 0, v106
  v_cvt_pk_bf16_f32 v107, 0, v107
  v_cvt_pk_bf16_f32 v108, 0, v108
  v_cvt_pk_bf16_f32 v109, 0, v109
  v_cvt_pk_bf16_f32 v110, 0, v110
  v_readfirstlane_b32 s6, v100
  v_readfirstlane_b32 s7, v100
  s_nop 1
  v_pk_add_f32 v[112:113], v[100:101], s[6:7] neg_lo:[0,1] neg_hi:[0,1]
  v_pk_add_f32 v[114:115], v[102:103], s[6:7] neg_lo:[0,1] neg_hi:[0,1]
  v_pk_add_f32 v[116:117], v[104:105], s[6:7] neg_lo:[0,1] neg_hi:[0,1]
  v_pk_add_f32 v[118:119], v[106:107], s[6:7] neg_lo:[0,1] neg_hi:[0,1]
  v_pk_add_f32 v[120:121], v[108:109], s[6:7] neg_lo:[0,1] neg_hi:[0,1]
  v_pk_add_f32 v[122:123], v[110:111], s[6:7] neg_lo:[0,1] neg_hi:[0,1]
  v_pk_add_f32 v[160:161], v[112:113], v[114:115]
  v_pk_mul_f32 v[162:163], v[112:113], v[112:113]
  v_pk_add_f32 v[164:165], v[116:117], v[118:119]
  v_pk_fma_f32 v[162:163], v[114:115], v[114:115], v[162:163]
  v_pk_add_f32 v[160:161], v[160:161], v[120:121]
  v_pk_fma_f32 v[162:163], v[116:117], v[116:117], v[162:163]
  v_pk_add_f32 v[160:161], v[160:161], v[164:165]
  v_pk_fma_f32 v[162:163], v[118:119], v[118:119], v[162:163]
  v_and_b32 v164, v122, v4
  v_pk_fma_f32 v[162:163], v[120:121], v[120:121], v[162:163]
  v_add_f32 v160, v160, v161
  v_fmac_f32 v162, v164, v164
  v_add_f32 v160, v160, v164
  v_add_f32 v162, v162, v163
  v_mov_b32 v164, 0x3acccccd
  s_mov_b64 exec, -1
  s_nop 0
  v_add_f32_dpp v160, v160, v160 quad_perm:[1,0,3,2] row_mask:0xf bank_mask:0xf
  v_add_f32_dpp v162, v162, v162 quad_perm:[1,0,3,2] row_mask:0xf bank_mask:0xf
  s_nop 0
  v_add_f32_dpp v160, v160, v160 quad_perm:[2,3,0,1] row_mask:0xf bank_mask:0xf
  v_add_f32_dpp v162, v162, v162 quad_perm:[2,3,0,1] row_mask:0xf bank_mask:0xf
  s_nop 0
  v_add_f32_dpp v160, v160, v160 row_half_mirror row_mask:0xf bank_mask:0xf
  v_add_f32_dpp v162, v162, v162 row_half_mirror row_mask:0xf bank_mask:0xf
  s_nop 0
  v_add_f32_dpp v160, v160, v160 row_mirror row_mask:0xf bank_mask:0xf
  v_add_f32_dpp v162, v162, v162 row_mirror row_mask:0xf bank_mask:0xf
  s_nop 0
  v_add_f32_dpp v160, v160, v160 row_bcast:15 row_mask:0xa bank_mask:0xf
  v_add_f32_dpp v162, v162, v162 row_bcast:15 row_mask:0xa bank_mask:0xf
  s_nop 0
  v_add_f32_dpp v160, v160, v160 row_bcast:31 row_mask:0xc bank_mask:0xf
  v_add_f32_dpp v162, v162, v162 row_bcast:31 row_mask:0xc bank_mask:0xf
  v_readlane_b32 s4, v160, 63
  v_readlane_b32 s5, v162, 63
  s_nop 1
  v_mul_f32 v160, s4, v164
  v_mul_f32 v162, s5, v164
  s_mov_b32 exec_lo, 0x7fff7fff
  s_mov_b32 exec_hi, 0x7fff7fff
  v_fma_f32 v162, -v160, v160, v162
  v_add_f32 v160, s6, v160
  v_max_f32 v162, 0, v162
  v_cvt_pk_bf16_f32 v160, 0, v160
  v_cvt_pk_bf16_f32 v162, 0, v162
  v_mov_b32 v161, v160
  v_add_f32 v162, 0x3727c5ac, v162
  v_pk_add_f32 v[112:113], v[100:101], v[160:161] neg_lo:[0,1] neg_hi:[0,1]
  v_cvt_pk_bf16_f32 v162, 0, v162
  v_pk_add_f32 v[114:115], v[102:103], v[160:161] neg_lo:[0,1] neg_hi:[0,1]
  v_sqrt_f32 v162, v162
  v_pk_add_f32 v[116:117], v[104:105], v[160:161] neg_lo:[0,1] neg_hi:[0,1]
  v_pk_add_f32 v[118:119], v[106:107], v[160:161] neg_lo:[0,1] neg_hi:[0,1]
  v_pk_add_f32 v[120:121], v[108:109], v[160:161] neg_lo:[0,1] neg_hi:[0,1]
  v_pk_add_f32 v[122:123], v[110:111], v[160:161] neg_lo:[0,1] neg_hi:[0,1]
  v_cvt_pk_bf16_f32 v162, 0, v162
  v_cvt_pk_bf16_f32 v112, 0, v112
  v_rcp_f32 v162, v162
  v_cvt_pk_bf16_f32 v113, 0, v113
  v_cvt_pk_bf16_f32 v114, 0, v114
  v_cvt_pk_bf16_f32 v115, 0, v115
  v_cvt_pk_bf16_f32 v116, 0, v116
  v_cvt_pk_bf16_f32 v117, 0, v117
  v_cvt_pk_bf16_f32 v118, 0, v118
  v_cvt_pk_bf16_f32 v119, 0, v119
  v_cvt_pk_bf16_f32 v120, 0, v120
  v_cvt_pk_bf16_f32 v121, 0, v121
  v_cvt_pk_bf16_f32 v122, 0, v122
  v_mov_b32 v163, v162
  v_pk_mul_f32 v[112:113], v[112:113], v[162:163]
  v_pk_mul_f32 v[114:115], v[114:115], v[162:163]
  v_pk_mul_f32 v[116:117], v[116:117], v[162:163]
  v_pk_mul_f32 v[118:119], v[118:119], v[162:163]
  v_pk_mul_f32 v[120:121], v[120:121], v[162:163]
  v_pk_mul_f32 v[122:123], v[122:123], v[162:163]
  v_cvt_pk_bf16_f32 v112, 0, v112
  v_cvt_pk_bf16_f32 v113, 0, v113
  v_cvt_pk_bf16_f32 v114, 0, v114
  v_cvt_pk_bf16_f32 v115, 0, v115
  v_cvt_pk_bf16_f32 v116, 0, v116
  v_cvt_pk_bf16_f32 v117, 0, v117
  v_cvt_pk_bf16_f32 v118, 0, v118
  v_cvt_pk_bf16_f32 v119, 0, v119
  v_cvt_pk_bf16_f32 v120, 0, v120
  v_cvt_pk_bf16_f32 v121, 0, v121
  v_cvt_pk_bf16_f32 v122, 0, v122
  v_pk_add_f32 v[166:167], v[112:113], v[114:115]
  v_pk_mul_f32 v[168:169], v[112:113], v[112:113]
  v_pk_add_f32 v[170:171], v[116:117], v[118:119]
  v_pk_fma_f32 v[168:169], v[114:115], v[114:115], v[168:169]
  v_pk_add_f32 v[166:167], v[166:167], v[120:121]
  v_pk_fma_f32 v[168:169], v[116:117], v[116:117], v[168:169]
  v_pk_add_f32 v[166:167], v[166:167], v[170:171]
  v_pk_fma_f32 v[168:169], v[118:119], v[118:119], v[168:169]
  v_and_b32 v170, v122, v4
  v_pk_fma_f32 v[168:169], v[120:121], v[120:121], v[168:169]
  v_add_f32 v166, v166, v167
  v_fmac_f32 v168, v170, v170
  v_add_f32 v166, v166, v170
  v_add_f32 v168, v168, v169
  v_mov_b32 v170, 0x3acccccd
  s_mov_b64 exec, -1
  s_nop 0
  v_add_f32_dpp v166, v166, v166 quad_perm:[1,0,3,2] row_mask:0xf bank_mask:0xf
  v_add_f32_dpp v168, v168, v168 quad_perm:[1,0,3,2] row_mask:0xf bank_mask:0xf
  s_nop 0
  v_add_f32_dpp v166, v166, v166 quad_perm:[2,3,0,1] row_mask:0xf bank_mask:0xf
  v_add_f32_dpp v168, v168, v168 quad_perm:[2,3,0,1] row_mask:0xf bank_mask:0xf
  s_nop 0
  v_add_f32_dpp v166, v166, v166 row_half_mirror row_mask:0xf bank_mask:0xf
  v_add_f32_dpp v168, v168, v168 row_half_mirror row_mask:0xf bank_mask:0xf
  s_nop 0
  v_add_f32_dpp v166, v166, v166 row_mirror row_mask:0xf bank_mask:0xf
  v_add_f32_dpp v168, v168, v168 row_mirror row_mask:0xf bank_mask:0xf
  s_nop 0
  v_add_f32_dpp v166, v166, v166 row_bcast:15 row_mask:0xa bank_mask:0xf
  v_add_f32_dpp v168, v168, v168 row_bcast:15 row_mask:0xa bank_mask:0xf
  s_nop 0
  v_add_f32_dpp v166, v166, v166 row_bcast:31 row_mask:0xc bank_mask:0xf
  v_add_f32_dpp v168, v168, v168 row_bcast:31 row_mask:0xc bank_mask:0xf
  v_readlane_b32 s4, v166, 63
  v_readlane_b32 s5, v168, 63
  s_nop 1
  v_mul_f32 v166, s4, v170
  v_mul_f32 v168, s5, v170
  s_mov_b32 exec_lo, 0x7fff7fff
  s_mov_b32 exec_hi, 0x7fff7fff
  v_fma_f32 v168, -v166, v166, v168
  v_max_f32 v168, 0, v168
  v_cvt_pk_bf16_f32 v166, 0, v166
  v_cvt_pk_bf16_f32 v168, 0, v168
  v_mov_b32 v167, v166
  v_add_f32 v168, 0x3727c5ac, v168
  v_pk_add_f32 v[112:113], v[112:113], v[166:167] neg_lo:[0,1] neg_hi:[0,1]
  v_cvt_pk_bf16_f32 v168, 0, v168
  v_pk_add_f32 v[114:115], v[114:115], v[166:167] neg_lo:[0,1] neg_hi:[0,1]
  v_sqrt_f32 v168, v168
  v_pk_add_f32 v[116:117], v[116:117], v[166:167] neg_lo:[0,1] neg_hi:[0,1]
  v_pk_add_f32 v[118:119], v[118:119], v[166:167] neg_lo:[0,1] neg_hi:[0,1]
  v_pk_add_f32 v[120:121], v[120:121], v[166:167] neg_lo:[0,1] neg_hi:[0,1]
  v_pk_add_f32 v[122:123], v[122:123], v[166:167] neg_lo:[0,1] neg_hi:[0,1]
  v_cvt_pk_bf16_f32 v168, 0, v168
  v_cvt_pk_bf16_f32 v112, 0, v112
  v_rcp_f32 v168, v168
  v_cvt_pk_bf16_f32 v113, 0, v113
  v_cvt_pk_bf16_f32 v114, 0, v114
  v_cvt_pk_bf16_f32 v115, 0, v115
  v_cvt_pk_bf16_f32 v116, 0, v116
  v_cvt_pk_bf16_f32 v117, 0, v117
  v_cvt_pk_bf16_f32 v118, 0, v118
  v_cvt_pk_bf16_f32 v119, 0, v119
  v_cvt_pk_bf16_f32 v120, 0, v120
  v_cvt_pk_bf16_f32 v121, 0, v121
  v_cvt_pk_bf16_f32 v122, 0, v122
  v_mov_b32 v169, v168
  v_pk_mul_f32 v[112:113], v[112:113], v[168:169]
  v_pk_mul_f32 v[114:115], v[114:115], v[168:169]
  v_pk_mul_f32 v[116:117], v[116:117], v[168:169]
  v_pk_mul_f32 v[118:119], v[118:119], v[168:169]
  v_pk_mul_f32 v[120:121], v[120:121], v[168:169]
  v_pk_mul_f32 v[122:123], v[122:123], v[168:169]
  v_cvt_pk_bf16_f32 v112, 0, v112
  v_cvt_pk_bf16_f32 v113, 0, v113
  v_cvt_pk_bf16_f32 v114, 0, v114
  v_cvt_pk_bf16_f32 v115, 0, v115
  v_cvt_pk_bf16_f32 v116, 0, v116
  v_cvt_pk_bf16_f32 v117, 0, v117
  v_cvt_pk_bf16_f32 v118, 0, v118
  v_cvt_pk_bf16_f32 v119, 0, v119
  v_cvt_pk_bf16_f32 v120, 0, v120
  v_cvt_pk_bf16_f32 v121, 0, v121
  v_cvt_pk_bf16_f32 v122, 0, v122
  v_lshrrev_b32 v148, 15, v112
  ds_read_u16_d16_hi v124, v148 offset:21888
  v_lshrrev_b32 v149, 15, v113
  ds_read_u16_d16_hi v125, v149 offset:21888
  v_lshrrev_b32 v150, 15, v114
  ds_read_u16_d16_hi v126, v150 offset:21888
  v_lshrrev_b32 v151, 15, v115
  ds_read_u16_d16_hi v127, v151 offset:21888
  v_lshrrev_b32 v152, 15, v116
  ds_read_u16_d16_hi v128, v152 offset:21888
  v_lshrrev_b32 v153, 15, v117
  ds_read_u16_d16_hi v129, v153 offset:21888
  v_lshrrev_b32 v154, 15, v118
  ds_read_u16_d16_hi v130, v154 offset:21888
  v_lshrrev_b32 v155, 15, v119
  ds_read_u16_d16_hi v131, v155 offset:21888
  v_lshrrev_b32 v156, 15, v120
  ds_read_u16_d16_hi v132, v156 offset:21888
  v_lshrrev_b32 v157, 15, v121
  ds_read_u16_d16_hi v133, v157 offset:21888
  v_lshrrev_b32 v158, 15, v122
  ds_read_u16_d16_hi v134, v158 offset:21888
  v_bfi_b32 v122, v4, v122, 1.0
  v_min3_f32 v21, abs(v112), abs(v113), abs(v114)
  v_max3_f32 v22, abs(v112), abs(v113), abs(v114)
  v_min3_f32 v21, abs(v115), abs(v116), v21
  v_max3_f32 v22, abs(v115), abs(v116), v22
  v_min3_f32 v21, abs(v117), abs(v118), v21
  v_max3_f32 v22, abs(v117), abs(v118), v22
  v_min3_f32 v21, abs(v119), abs(v120), v21
  v_max3_f32 v22, abs(v119), abs(v120), v22
  v_min3_f32 v21, abs(v121), abs(v122), v21
  v_max3_f32 v22, abs(v121), abs(v122), v22
  v_cmp_gt_f32 vcc, 0x32000000, v21
  v_mov_b32 v21, 0x42000000
  v_cmp_le_f32 s[4:5], v21, v22
  s_waitcnt lgkmcnt(0)
  s_or_b64 vcc, vcc, s[4:5]
  s_cbranch_scc1 L_direct
L_lookup:
  v_pk_add_f32 v[124:125], v[124:125], v[100:101]
  v_pk_add_f32 v[126:127], v[126:127], v[102:103]
  v_pk_add_f32 v[128:129], v[128:129], v[104:105]
  v_pk_add_f32 v[130:131], v[130:131], v[106:107]
  v_pk_add_f32 v[132:133], v[132:133], v[108:109]
  v_pk_add_f32 v[134:135], v[134:135], v[110:111]
  v_cvt_pk_bf16_f32 v124, v124, v125
  v_cvt_pk_bf16_f32 v126, v126, v127
  v_cvt_pk_bf16_f32 v128, v128, v129
  v_cvt_pk_bf16_f32 v130, v130, v131
  v_cvt_pk_bf16_f32 v132, v132, v133
  v_cvt_pk_bf16_f32 v134, v134, v135
  buffer_store_short v124, v19, s[36:39], 0 offen offset:0
  buffer_store_short_d16_hi v124, v19, s[36:39], 0 offen offset:120
  buffer_store_short v126, v19, s[36:39], 0 offen offset:240
  buffer_store_short_d16_hi v126, v19, s[36:39], 0 offen offset:360
  buffer_store_short v128, v19, s[36:39], 0 offen offset:480
  buffer_store_short_d16_hi v128, v19, s[36:39], 0 offen offset:600
  buffer_store_short v130, v19, s[36:39], 0 offen offset:720
  buffer_store_short_d16_hi v130, v19, s[36:39], 0 offen offset:840
  buffer_store_short v132, v19, s[36:39], 0 offen offset:960
  buffer_store_short_d16_hi v132, v19, s[36:39], 0 offen offset:1080
  buffer_store_short v134, v19, s[36:39], 0 offen offset:1200
  s_cmp_lg_u32 s51, 0
  s_cbranch_scc1 L_start
  s_mov_b64 exec, -1
L_done:
L_end:
  s_endpgm
L_direct:
  s_cmp_lg_u32 s51, 0
  s_cbranch_scc1 L_lookup
  s_mov_b64 exec, -1
  v_lshrrev_b32 v20, 3, v1
  v_mul_u32_u24 v20, 2320, v20
  v_and_b32 v21, 7, v1
  v_mul_u32_u24 v21, 288, v21
  v_add_u32 v20, v20, v21
  v_add_u32 v20, 18432, v20
  v_bfe_u32 v21, v112, 23, 8
  v_subrev_u32 v21, 100, v21
  s_mov_b32 exec_lo, 0x7fff7fff
  s_mov_b32 exec_hi, 0x7fff7fff
  v_cmp_le_u32 s[4:5], 32, v21
  s_mov_b64 exec, -1
L_dir0:
  s_nop 1
  s_cmp_eq_u64 s[4:5], 0
  s_cbranch_scc1 L_dirx0
  s_ff1_i32_b64 s57, s[4:5]
  v_readlane_b32 s58, v112, s57
  s_call_b64 s[6:7], L_eval
  v_cmp_eq_u32 vcc, s58, v112
  s_nop 1
  v_cndmask_b32 v124, v124, v90, vcc
  s_andn2_b64 s[4:5], s[4:5], vcc
  s_branch L_dir0
L_dirx0:
  v_bfe_u32 v21, v113, 23, 8
  v_subrev_u32 v21, 100, v21
  s_mov_b32 exec_lo, 0x7fff7fff
  s_mov_b32 exec_hi, 0x7fff7fff
  v_cmp_le_u32 s[4:5], 32, v21
  s_mov_b64 exec, -1
L_dir1:
  s_nop 1
  s_cmp_eq_u64 s[4:5], 0
  s_cbranch_scc1 L_dirx1
  s_ff1_i32_b64 s57, s[4:5]
  v_readlane_b32 s58, v113, s57
  s_call_b64 s[6:7], L_eval
  v_cmp_eq_u32 vcc, s58, v113
  s_nop 1
  v_cndmask_b32 v125, v125, v90, vcc
  s_andn2_b64 s[4:5], s[4:5], vcc
  s_branch L_dir1
L_dirx1:
  v_bfe_u32 v21, v114, 23, 8
  v_subrev_u32 v21, 100, v21
  s_mov_b32 exec_lo, 0x7fff7fff
  s_mov_b32 exec_hi, 0x7fff7fff
  v_cmp_le_u32 s[4:5], 32, v21
  s_mov_b64 exec, -1
L_dir2:
  s_nop 1
  s_cmp_eq_u64 s[4:5], 0
  s_cbranch_scc1 L_dirx2
  s_ff1_i32_b64 s57, s[4:5]
  v_readlane_b32 s58, v114, s57
  s_call_b64 s[6:7], L_eval
  v_cmp_eq_u32 vcc, s58, v114
  s_nop 1
  v_cndmask_b32 v126, v126, v90, vcc
  s_andn2_b64 s[4:5], s[4:5], vcc
  s_branch L_dir2
L_dirx2:
  v_bfe_u32 v21, v115, 23, 8
  v_subrev_u32 v21, 100, v21
  s_mov_b32 exec_lo, 0x7fff7fff
  s_mov_b32 exec_hi, 0x7fff7fff
  v_cmp_le_u32 s[4:5], 32, v21
  s_mov_b64 exec, -1
L_dir3:
  s_nop 1
  s_cmp_eq_u64 s[4:5], 0
  s_cbranch_scc1 L_dirx3
  s_ff1_i32_b64 s57, s[4:5]
  v_readlane_b32 s58, v115, s57
  s_call_b64 s[6:7], L_eval
  v_cmp_eq_u32 vcc, s58, v115
  s_nop 1
  v_cndmask_b32 v127, v127, v90, vcc
  s_andn2_b64 s[4:5], s[4:5], vcc
  s_branch L_dir3
L_dirx3:
  v_bfe_u32 v21, v116, 23, 8
  v_subrev_u32 v21, 100, v21
  s_mov_b32 exec_lo, 0x7fff7fff
  s_mov_b32 exec_hi, 0x7fff7fff
  v_cmp_le_u32 s[4:5], 32, v21
  s_mov_b64 exec, -1
L_dir4:
  s_nop 1
  s_cmp_eq_u64 s[4:5], 0
  s_cbranch_scc1 L_dirx4
  s_ff1_i32_b64 s57, s[4:5]
  v_readlane_b32 s58, v116, s57
  s_call_b64 s[6:7], L_eval
  v_cmp_eq_u32 vcc, s58, v116
  s_nop 1
  v_cndmask_b32 v128, v128, v90, vcc
  s_andn2_b64 s[4:5], s[4:5], vcc
  s_branch L_dir4
L_dirx4:
  v_bfe_u32 v21, v117, 23, 8
  v_subrev_u32 v21, 100, v21
  s_mov_b32 exec_lo, 0x7fff7fff
  s_mov_b32 exec_hi, 0x7fff7fff
  v_cmp_le_u32 s[4:5], 32, v21
  s_mov_b64 exec, -1
L_dir5:
  s_nop 1
  s_cmp_eq_u64 s[4:5], 0
  s_cbranch_scc1 L_dirx5
  s_ff1_i32_b64 s57, s[4:5]
  v_readlane_b32 s58, v117, s57
  s_call_b64 s[6:7], L_eval
  v_cmp_eq_u32 vcc, s58, v117
  s_nop 1
  v_cndmask_b32 v129, v129, v90, vcc
  s_andn2_b64 s[4:5], s[4:5], vcc
  s_branch L_dir5
L_dirx5:
  v_bfe_u32 v21, v118, 23, 8
  v_subrev_u32 v21, 100, v21
  s_mov_b32 exec_lo, 0x7fff7fff
  s_mov_b32 exec_hi, 0x7fff7fff
  v_cmp_le_u32 s[4:5], 32, v21
  s_mov_b64 exec, -1
L_dir6:
  s_nop 1
  s_cmp_eq_u64 s[4:5], 0
  s_cbranch_scc1 L_dirx6
  s_ff1_i32_b64 s57, s[4:5]
  v_readlane_b32 s58, v118, s57
  s_call_b64 s[6:7], L_eval
  v_cmp_eq_u32 vcc, s58, v118
  s_nop 1
  v_cndmask_b32 v130, v130, v90, vcc
  s_andn2_b64 s[4:5], s[4:5], vcc
  s_branch L_dir6
L_dirx6:
  v_bfe_u32 v21, v119, 23, 8
  v_subrev_u32 v21, 100, v21
  s_mov_b32 exec_lo, 0x7fff7fff
  s_mov_b32 exec_hi, 0x7fff7fff
  v_cmp_le_u32 s[4:5], 32, v21
  s_mov_b64 exec, -1
L_dir7:
  s_nop 1
  s_cmp_eq_u64 s[4:5], 0
  s_cbranch_scc1 L_dirx7
  s_ff1_i32_b64 s57, s[4:5]
  v_readlane_b32 s58, v119, s57
  s_call_b64 s[6:7], L_eval
  v_cmp_eq_u32 vcc, s58, v119
  s_nop 1
  v_cndmask_b32 v131, v131, v90, vcc
  s_andn2_b64 s[4:5], s[4:5], vcc
  s_branch L_dir7
L_dirx7:
  v_bfe_u32 v21, v120, 23, 8
  v_subrev_u32 v21, 100, v21
  s_mov_b32 exec_lo, 0x7fff7fff
  s_mov_b32 exec_hi, 0x7fff7fff
  v_cmp_le_u32 s[4:5], 32, v21
  s_mov_b64 exec, -1
L_dir8:
  s_nop 1
  s_cmp_eq_u64 s[4:5], 0
  s_cbranch_scc1 L_dirx8
  s_ff1_i32_b64 s57, s[4:5]
  v_readlane_b32 s58, v120, s57
  s_call_b64 s[6:7], L_eval
  v_cmp_eq_u32 vcc, s58, v120
  s_nop 1
  v_cndmask_b32 v132, v132, v90, vcc
  s_andn2_b64 s[4:5], s[4:5], vcc
  s_branch L_dir8
L_dirx8:
  v_bfe_u32 v21, v121, 23, 8
  v_subrev_u32 v21, 100, v21
  s_mov_b32 exec_lo, 0x7fff7fff
  s_mov_b32 exec_hi, 0x7fff7fff
  v_cmp_le_u32 s[4:5], 32, v21
  s_mov_b64 exec, -1
L_dir9:
  s_nop 1
  s_cmp_eq_u64 s[4:5], 0
  s_cbranch_scc1 L_dirx9
  s_ff1_i32_b64 s57, s[4:5]
  v_readlane_b32 s58, v121, s57
  s_call_b64 s[6:7], L_eval
  v_cmp_eq_u32 vcc, s58, v121
  s_nop 1
  v_cndmask_b32 v133, v133, v90, vcc
  s_andn2_b64 s[4:5], s[4:5], vcc
  s_branch L_dir9
L_dirx9:
  v_bfe_u32 v21, v122, 23, 8
  v_subrev_u32 v21, 100, v21
  s_mov_b32 exec_lo, 0x7fff7fff
  s_mov_b32 exec_hi, 0x7fff7fff
  v_cmp_le_u32 s[4:5], 32, v21
  s_mov_b64 exec, -1
L_dir10:
  s_nop 1
  s_cmp_eq_u64 s[4:5], 0
  s_cbranch_scc1 L_dirx10
  s_ff1_i32_b64 s57, s[4:5]
  v_readlane_b32 s58, v122, s57
  s_call_b64 s[6:7], L_eval
  v_cmp_eq_u32 vcc, s58, v122
  s_nop 1
  v_cndmask_b32 v134, v134, v90, vcc
  s_andn2_b64 s[4:5], s[4:5], vcc
  s_branch L_dir10
L_dirx10:
  s_mov_b32 exec_lo, 0x7fff7fff
  s_mov_b32 exec_hi, 0x7fff7fff
  s_branch L_lookup
L_eval:
  s_nop 1
  v_mov_b32 v88, s58
  v_mov_b32 v89, s58
  v_mov_b32 v90, 0
  v_mov_b32 v91, 0
  v_mov_b32 v94, v20
  s_waitcnt lgkmcnt(0)
  ds_read_b128 v[64:67], v94 offset:0
  ds_read_b128 v[68:71], v94 offset:16
  ds_read_b128 v[72:75], v94 offset:32
  ds_read_b128 v[76:79], v94 offset:48
  ds_read_b128 v[80:83], v94 offset:64
  ds_read_b128 v[84:87], v94 offset:80
  v_add_u32 v94, 96, v94
  s_call_b64 s[74:75], L_tab
  s_call_b64 s[74:75], L_tab
  s_call_b64 s[74:75], L_tab
  v_add_f32 v90, v90, v91
  s_nop 1
  v_add_f32_dpp v90, v90, v90 quad_perm:[1,0,3,2] row_mask:0xf bank_mask:0xf
  s_nop 1
  v_add_f32_dpp v90, v90, v90 quad_perm:[2,3,0,1] row_mask:0xf bank_mask:0xf
  s_nop 1
  v_add_f32_dpp v90, v90, v90 row_half_mirror row_mask:0xf bank_mask:0xf
  s_nop 1
  v_add_f32_dpp v90, v90, v90 row_mirror row_mask:0xf bank_mask:0xf
  s_nop 1
  v_add_f32_dpp v90, v90, v90 row_bcast:15 row_mask:0xa bank_mask:0xf
  s_nop 1
  v_add_f32_dpp v90, v90, v90 row_bcast:31 row_mask:0xc bank_mask:0xf
  s_nop 0
  v_readlane_b32 s57, v90, 63
  s_nop 1
  v_mov_b32 v90, s57
  v_cvt_pk_bf16_f32 v90, 0, v90
  v_add_f32 v90, s69, v90
  v_cvt_pk_bf16_f32 v90, v90, v90
  v_and_b32 v90, 0xffff0000, v90
  s_setpc_b64 s[6:7]
L_tab:
  s_waitcnt lgkmcnt(0)
  v_pk_mul_f32 v[64:65], v[88:89], v[64:65]
  v_pk_mul_f32 v[66:67], v[88:89], v[66:67]
  v_pk_mul_f32 v[68:69], v[88:89], v[68:69]
  v_pk_mul_f32 v[70:71], v[88:89], v[70:71]
  v_cvt_pk_bf16_f32 v64, 0, v64
  v_cvt_pk_bf16_f32 v65, 0, v65
  v_cvt_pk_bf16_f32 v66, 0, v66
  v_cvt_pk_bf16_f32 v67, 0, v67
  v_cvt_pk_bf16_f32 v68, 0, v68
  v_cvt_pk_bf16_f32 v69, 0, v69
  v_cvt_pk_bf16_f32 v70, 0, v70
  v_cvt_pk_bf16_f32 v71, 0, v71
  v_pk_add_f32 v[64:65], v[64:65], v[72:73]
  v_pk_add_f32 v[66:67], v[66:67], v[74:75]
  v_pk_add_f32 v[68:69], v[68:69], v[76:77]
  v_pk_add_f32 v[70:71], v[70:71], v[78:79]
  v_cvt_pk_bf16_f32 v64, 0, v64
  v_cvt_pk_bf16_f32 v65, 0, v65
  v_cvt_pk_bf16_f32 v66, 0, v66
  v_cvt_pk_bf16_f32 v67, 0, v67
  v_cvt_pk_bf16_f32 v68, 0, v68
  v_cvt_pk_bf16_f32 v69, 0, v69
  v_cvt_pk_bf16_f32 v70, 0, v70
  v_cvt_pk_bf16_f32 v71, 0, v71
  v_pk_mul_f32 v[72:73], v[64:65], v[64:65]
  v_pk_mul_f32 v[74:75], v[66:67], v[66:67]
  v_pk_mul_f32 v[76:77], v[68:69], v[68:69]
  v_pk_mul_f32 v[78:79], v[70:71], v[70:71]
  v_pk_fma_f32 v[72:73], v[72:73], v[92:93], s[70:71]
  v_pk_fma_f32 v[74:75], v[74:75], v[92:93], s[70:71]
  v_pk_fma_f32 v[76:77], v[76:77], v[92:93], s[70:71]
  v_pk_fma_f32 v[78:79], v[78:79], v[92:93], s[70:71]
  v_pk_mul_f32 v[72:73], v[72:73], v[64:65]
  v_pk_mul_f32 v[74:75], v[74:75], v[66:67]
  v_pk_mul_f32 v[76:77], v[76:77], v[68:69]
  v_pk_mul_f32 v[78:79], v[78:79], v[70:71]
  v_exp_f32 v72, v72
  v_exp_f32 v73, v73
  v_exp_f32 v74, v74
  v_exp_f32 v75, v75
  v_exp_f32 v76, v76
  v_exp_f32 v77, v77
  v_exp_f32 v78, v78
  v_exp_f32 v79, v79
  v_pk_add_f32 v[72:73], v[72:73], s[72:73]
  v_pk_add_f32 v[74:75], v[74:75], s[72:73]
  v_pk_add_f32 v[76:77], v[76:77], s[72:73]
  v_pk_add_f32 v[78:79], v[78:79], s[72:73]
  v_rcp_f32 v72, v72
  v_rcp_f32 v73, v73
  v_rcp_f32 v74, v74
  v_rcp_f32 v75, v75
  v_rcp_f32 v76, v76
  v_rcp_f32 v77, v77
  v_rcp_f32 v78, v78
  v_rcp_f32 v79, v79
  v_pk_mul_f32 v[64:65], v[64:65], v[72:73]
  v_pk_mul_f32 v[66:67], v[66:67], v[74:75]
  v_pk_mul_f32 v[68:69], v[68:69], v[76:77]
  v_pk_mul_f32 v[70:71], v[70:71], v[78:79]
  v_cvt_pk_bf16_f32 v64, 0, v64
  v_cvt_pk_bf16_f32 v65, 0, v65
  v_cvt_pk_bf16_f32 v66, 0, v66
  v_cvt_pk_bf16_f32 v67, 0, v67
  v_cvt_pk_bf16_f32 v68, 0, v68
  v_cvt_pk_bf16_f32 v69, 0, v69
  v_cvt_pk_bf16_f32 v70, 0, v70
  v_cvt_pk_bf16_f32 v71, 0, v71
  v_pk_fma_f32 v[90:91], v[64:65], v[80:81], v[90:91]
  v_pk_fma_f32 v[90:91], v[66:67], v[82:83], v[90:91]
  v_pk_fma_f32 v[90:91], v[68:69], v[84:85], v[90:91]
  v_pk_fma_f32 v[90:91], v[70:71], v[86:87], v[90:91]
  ds_read_b128 v[64:67], v94 offset:0
  ds_read_b128 v[68:71], v94 offset:16
  ds_read_b128 v[72:75], v94 offset:32
  ds_read_b128 v[76:79], v94 offset:48
  ds_read_b128 v[80:83], v94 offset:64
  ds_read_b128 v[84:87], v94 offset:80
  v_add_u32 v94, 96, v94
  s_setpc_b64 s[74:75]
.section .rodata,"a"
.p2align 6
.amdhsa_kernel sequential_preLN__mha_block_cached__mixer_token_mlp__decode_kernel
  .amdhsa_next_free_vgpr 484
  .amdhsa_next_free_sgpr 102
  .amdhsa_accum_offset 244
  .amdhsa_group_segment_fixed_size 0
  .amdhsa_kernarg_size 104
  .amdhsa_user_sgpr_count 2
  .amdhsa_user_sgpr_kernarg_segment_ptr 1
  .amdhsa_system_sgpr_workgroup_id_x 1
  .amdhsa_float_denorm_mode_32 3
.end_amdhsa_kernel
```
